```python
import torch

def _softmax(x, axis=-1):
    return torch.softmax(x, dim=axis)
def _gelu(x):
    return torch.nn.functional.gelu(x, approximate="tanh")
def _silu(x):
    return torch.nn.functional.silu(x)
def _sigmoid(x):
    return torch.sigmoid(x)
def _layernorm(x, axis=-1, eps=1e-5):
    m = x.mean(dim=axis, keepdim=True)
    v = x.var(dim=axis, keepdim=True, unbiased=False)
    return (x - m) / torch.sqrt(v + eps)
def _scatter_add(tgt, idx, src, axis=0):
    return tgt.clone().index_add_(axis, idx, src)
def _segment_sum(src, seg, n):
    out = torch.zeros((n,) + src.shape[1:], dtype=src.dtype)
    return out.index_add_(0, seg, src)
def _pad(x, pw):
    flat = tuple(v for pair in reversed(pw) for v in pair)
    return torch.nn.functional.pad(x, flat)

kernel_name = 'sequential_preLN__linear_kernel_hedgehog__dense_activation_gelu__prompt'

def setup_inputs():

    _w = (lambda a: (lambda t: t.to(torch.bfloat16) if t.is_floating_point() else t)(torch.as_tensor(a)))
    def _A_setup():
        B, S, D, H = 1, 2048, 512, 32
        Dh = D // H
        return {
            "x": _w((lambda *s: torch.randn(*s, dtype=torch.bfloat16) * 0.05)(B, S, D)),
            "wqkv": _w((lambda *s: torch.randn(*s, dtype=torch.bfloat16) * 0.2)(D, 3 * D)),
            "w_phi": _w((lambda *s: torch.randn(*s, dtype=torch.bfloat16) * 0.2)(H, Dh, Dh) * (Dh ** -0.5)),
            "wo": _w((lambda *s: torch.randn(*s, dtype=torch.bfloat16) * 0.05)(D, D)),
        }
    _A_in = _A_setup()

    def _B_setup():
        B, S, D, F = 1, 2048, 512, 1376
        return {
            "x": _w((lambda *s: torch.randn(*s, dtype=torch.bfloat16) * 0.05)(B, S, D)),
            "w1": _w((lambda *s: torch.randn(*s, dtype=torch.bfloat16) * 1.6)(D, F) * (D ** -0.5)),
            "b1": _w((lambda *s: torch.randn(*s, dtype=torch.bfloat16) * 0.1)(F) * 0.01),
            "w2": _w((lambda *s: torch.randn(*s, dtype=torch.bfloat16) * 0.1)(F, D) * (F ** -0.5)),
            "b2": _w((lambda *s: torch.randn(*s, dtype=torch.bfloat16) * 0.1)(D) * 0.01),
        }
    _B_in = _B_setup()

    return {
        "A_x": _A_in["x"],
        "A_wqkv": _A_in["wqkv"],
        "A_w_phi": _A_in["w_phi"],
        "A_wo": _A_in["wo"],
        "B_x": _B_in["x"],
        "B_w1": _B_in["w1"],
        "B_b1": _B_in["b1"],
        "B_w2": _B_in["w2"],
        "B_b2": _B_in["b2"],
    }

def reference(A_x, A_wqkv, A_w_phi, A_wo, B_x, B_w1, B_b1, B_w2, B_b2):
    def _A_ref(x, wqkv, w_phi, wo):
        B, S, D = x.shape
        H = 32; Dh = D // H
        qkv = (lambda x, *d: x.permute(*d))((x @ wqkv).reshape(B, S, 3, H, Dh), 2, 0, 3, 1, 4)
        q, k, v = qkv[0], qkv[1], qkv[2]
        pq = torch.einsum("bhsd,hdf->bhsf", q, w_phi)
        pk = torch.einsum("bhsd,hdf->bhsf", k, w_phi)
        phi_q = torch.concatenate([_softmax(pq, axis=-1), _softmax(-pq, axis=-1)], axis=-1)
        phi_k = torch.concatenate([_softmax(pk, axis=-1), _softmax(-pk, axis=-1)], axis=-1)
        kv = torch.einsum("bhsf,bhsd->bhfd", phi_k, v)
        z  = torch.einsum("bhsf->bhf", phi_k)
        num = torch.einsum("bhqf,bhfd->bhqd", phi_q, kv)
        den = torch.einsum("bhqf,bhf->bhq", phi_q, z)[..., None] + 1e-6
        o = num / den
        return (lambda x, *d: x.permute(*d))(o, 0, 2, 1, 3).reshape(B, S, D) @ wo

    def _B_ref(x, w1, b1, w2, b2):
        h = torch.einsum("bsd,df->bsf", x, w1) + b1
        h = _gelu(h)
        return torch.einsum("bsf,fd->bsd", h, w2) + b2

    x = A_x
    h = x + _A_ref(_layernorm(x, axis=-1), A_wqkv, A_w_phi, A_wo)
    h2 = h + _B_ref(_layernorm(h, axis=-1), B_w1, B_b1, B_w2, B_b2)
    return h2
```

```asm
; @launch grid=(256,1,1) block=(256,1,1) lds=163840
.amdgcn_target "amdgcn-amd-amdhsa--gfx950"
.text
.globl sequential_preLN__linear_kernel_hedgehog__dense_activation_gelu__prompt_kernel
.p2align 8
.type sequential_preLN__linear_kernel_hedgehog__dense_activation_gelu__prompt_kernel,@function
sequential_preLN__linear_kernel_hedgehog__dense_activation_gelu__prompt_kernel:
    s_cmp_ge_u32 s2, 256
    s_cbranch_scc1 L_end
    s_load_dwordx2 s[24:25], s[0:1], 0
    s_load_dwordx2 s[28:29], s[0:1], 8
    s_load_dwordx2 s[32:33], s[0:1], 88
    s_load_dwordx2 s[60:61], s[0:1], 16
    s_load_dwordx2 s[36:37], s[0:1], 24
    s_load_dwordx2 s[40:41], s[0:1], 40
    s_load_dwordx2 s[4:5], s[0:1], 48
    s_load_dwordx2 s[44:45], s[0:1], 56
    s_load_dwordx2 s[8:9], s[0:1], 64
    s_load_dwordx2 s[56:57], s[0:1], 72
    s_getpc_b64 s[98:99]
L_pc:
    v_lshlrev_b32 v4, 7, v0
    v_min_u32 v4, L_last-L_pc, v4
    global_load_dword v91, v4, s[98:99]
    v_and_b32 v1, 63, v0
    v_lshrrev_b32 v4, 6, v0
    v_lshrrev_b32 v3, 4, v1
    v_readfirstlane_b32 s3, v4
    s_and_b32 s64, s2, 7
    s_lshr_b32 s65, s2, 3
    s_lshr_b32 s68, s65, 3
    s_and_b32 s67, s65, 7
    s_lshl_b32 s66, s64, 2
    s_add_u32 s66, s66, s68
    s_lshl_b32 s22, s3, 11
    s_lshl_b32 s23, s3, 12
    s_lshl_b32 s73, s3, 4
    v_lshrrev_b32 v4, 3, v1
    v_add_u32 v4, s73, v4
    v_and_b32 v5, 7, v1
    v_xor_b32 v5, v5, v3
    v_lshlrev_b32 v5, 4, v5
    v_lshl_add_u32 v9, v4, 10, v5
    v_xor_b32 v10, 64, v9
    v_add_u32 v10, 7168, v10
    v_and_b32 v7, 1, v3
    v_bfe_u32 v5, v1, 1, 2
    v_xor_b32 v5, v5, v7
    v_lshlrev_b32 v5, 5, v5
    v_and_b32 v6, 1, v1
    v_lshl_add_u32 v5, v6, 4, v5
    v_mul_u32_u24 v4, 3072, v4
    v_add_u32 v13, v4, v5
    v_add_u32 v11, 1024, v13
    v_xor_b32 v12, 64, v13
    v_add_u32 v12, 23552, v12
    s_mov_b32 s73, s64
    s_lshl_b32 s73, s73, 7
    s_and_b32 s12, s73, 0x380
    s_add_u32 s73, s73, 128
    s_and_b32 s13, s73, 0x380
    s_add_u32 s73, s73, 128
    s_and_b32 s14, s73, 0x380
    s_add_u32 s73, s73, 128
    s_and_b32 s15, s73, 0x380
    s_add_u32 s73, s73, 128
    s_and_b32 s16, s73, 0x380
    s_add_u32 s73, s73, 128
    s_and_b32 s17, s73, 0x380
    s_add_u32 s73, s73, 128
    s_and_b32 s18, s73, 0x380
    s_add_u32 s73, s73, 128
    s_and_b32 s19, s73, 0x380
    s_lshl_b32 s73, s66, 16
    s_lshl_b32 s74, s67, 7
    s_sub_u32 s30, 1572864, s74
    v_and_b32 v93, 15, v1
    v_min_u32 v94, 11, v93
    v_lshlrev_b32 v93, 7, v93
    v_lshlrev_b32 v94, 10, v94
    s_lshl_b32 s75, s65, 2
    s_add_u32 s75, s75, s3
    s_mul_i32 s75, s75, 12288
    s_add_u32 s75, s75, 384
    s_mov_b32 s62, 1572864
    s_mov_b32 s63, 0x20000
    s_mov_b32 s26, 65536
    s_mov_b32 s27, 0x20000
    s_mov_b32 s31, 0x20000
    s_waitcnt lgkmcnt(0)
    s_add_u32 s24, s24, s73
    s_addc_u32 s25, s25, 0
    s_and_b32 s25, s25, 0xffff
    s_mov_b64 s[48:49], s[60:61]
    s_mov_b32 s60, s28
    s_and_b32 s61, s29, 0xffff
    s_add_u32 s28, s28, s74
    s_addc_u32 s29, s29, 0
    s_and_b32 s29, s29, 0xffff
    s_lshl_b32 s73, s67, 13
    s_add_u32 s73, s73, s22
    buffer_load_dword v92, v93, s[24:27], s73 offen
    buffer_load_dword v92, v94, s[60:63], s75 offen
    s_add_u32 m0, s22, 0
    s_nop 0
    buffer_load_dwordx4 v9, s[24:27], s12 offen  lds
    buffer_load_dwordx4 v10, s[24:27], s12 offen offset:1024  lds
    s_load_dword s70, s[32:33], 0
    v_and_b32 v2, 15, v1
    s_add_u32 m0, s22, 8192
    v_and_b32 v5, 31, v1
    buffer_load_dwordx4 v9, s[24:27], s13 offen  lds
    v_lshrrev_b32 v6, 5, v1
    v_lshlrev_b32 v8, 4, v1
    v_lshrrev_b32 v4, 1, v2
    buffer_load_dwordx4 v10, s[24:27], s13 offen offset:1024  lds
    v_xor_b32 v4, v4, v3
    s_mul_i32 s79, s12, 1536
    v_lshlrev_b32 v4, 4, v4
    s_add_u32 m0, s23, 65536
    v_lshl_add_u32 v4, v2, 7, v4
    buffer_load_dwordx4 v11, s[28:31], s79 offen offset:0 lds
    s_xor_b32 s75, s22, 0
    v_add_u32 v17, s75, v4
    v_xor_b32 v21, 64, v17
    buffer_load_dwordx4 v11, s[28:31], s79 offen offset:1024 lds
    s_xor_b32 s75, s22, 2048
    v_add_u32 v18, s75, v4
    v_xor_b32 v22, 64, v18
    buffer_load_dwordx4 v12, s[28:31], s79 offen offset:2048 lds
    s_xor_b32 s75, s22, 4096
    v_add_u32 v19, s75, v4
    v_xor_b32 v23, 64, v19
    buffer_load_dwordx4 v12, s[28:31], s79 offen offset:3072 lds
    s_xor_b32 s75, s22, 6144
    s_add_u32 m0, s22, 16384
    v_add_u32 v20, s75, v4
    buffer_load_dwordx4 v9, s[24:27], s14 offen  lds
    v_xor_b32 v24, 64, v20
    v_lshrrev_b32 v14, 3, v2
    v_lshl_or_b32 v14, v7, 1, v14
    buffer_load_dwordx4 v10, s[24:27], s14 offen offset:1024  lds
    v_xor_b32 v14, s3, v14
    s_mul_i32 s79, s13, 1536
    v_lshlrev_b32 v4, 5, v14
    s_add_u32 m0, s23, 81920
    v_lshrrev_b32 v14, 2, v2
    buffer_load_dwordx4 v11, s[28:31], s79 offen offset:0 lds
    v_lshl_add_u32 v4, v14, 7, v4
    v_and_b32 v15, 3, v2
    v_lshl_add_u32 v4, v15, 3, v4
    buffer_load_dwordx4 v11, s[28:31], s79 offen offset:1024 lds
    v_cmp_eq_u32 s[80:81], 1, v15
    v_cmp_eq_u32 s[82:83], 2, v15
    v_cmp_eq_u32 s[84:85], 3, v15
    buffer_load_dwordx4 v12, s[28:31], s79 offen offset:2048 lds
    v_lshl_add_u32 v16, v3, 10, v4
    v_add_u32 v16, 98304, v16
    v_lshl_add_u32 v4, v3, 11, v4
    buffer_load_dwordx4 v12, s[28:31], s79 offen offset:3072 lds
    v_add_u32 v14, 0x10000, v4
    s_add_u32 m0, s22, 24576
    v_add_u32 v15, 0x20000, v4
    buffer_load_dwordx4 v9, s[24:27], s15 offen  lds
    v_mov_b32 v32, 0x3f803f80
    v_mov_b32 v33, 0x3f803f80
    v_mov_b32 v34, 0x3f803f80
    buffer_load_dwordx4 v10, s[24:27], s15 offen offset:1024  lds
    v_mov_b32 v35, 0x3f803f80
    s_and_b32 s33, s33, 0xffff
    s_mov_b32 s34, 16777216
    s_mov_b32 s35, 0x20000
    s_and_b32 s92, s3, 1
    s_lshr_b32 s93, s3, 1
    s_lshl_b32 s72, s3, 10
    s_lshl_b32 s69, s67, 2
    s_add_u32 s69, s69, s3
    s_mov_b64 s[60:61], s[48:49]
    s_and_b32 s61, s61, 0xffff
    s_mov_b32 s62, 16384
    s_mov_b32 s63, 0x20000
    s_mul_i32 s75, s3, 192
    s_add_u32 s75, s75, 0
    v_add_u32 v4, s75, v1
    v_mul_u32_u24 v244, 0xaaab, v4
    v_lshrrev_b32 v244, 19, v244
    v_mul_u32_u24 v255, 12, v244
    v_sub_u32 v4, v4, v255
    v_mul_u32_u24 v244, 2752, v244
    v_lshl_add_u32 v244, v4, 4, v244
    s_mul_i32 s75, s3, 192
    s_add_u32 s75, s75, 64
    v_add_u32 v4, s75, v1
    v_mul_u32_u24 v245, 0xaaab, v4
    v_lshrrev_b32 v245, 19, v245
    v_mul_u32_u24 v255, 12, v245
    v_sub_u32 v4, v4, v255
    v_mul_u32_u24 v245, 2752, v245
    v_lshl_add_u32 v245, v4, 4, v245
    s_mul_i32 s75, s3, 192
    s_add_u32 s75, s75, 128
    v_add_u32 v4, s75, v1
    v_mul_u32_u24 v246, 0xaaab, v4
    v_lshrrev_b32 v246, 19, v246
    v_mul_u32_u24 v255, 12, v246
    v_sub_u32 v4, v4, v255
    v_mul_u32_u24 v246, 2752, v246
    v_lshl_add_u32 v246, v4, 4, v246
    s_getreg_b32 s71, hwreg(HW_REG_XCC_ID)
    s_xor_b32 s73, s3, 0
    s_lshl_b32 s74, s73, 7
    s_add_u32 s74, s74, 65536
    v_lshl_add_u32 v200, v2, 3, s74
    s_lshl_b32 s74, s73, 6
    s_add_u32 s74, s74, 65536
    v_lshl_add_u32 v204, v3, 4, s74
    s_xor_b32 s73, s3, 1
    s_lshl_b32 s74, s73, 7
    s_add_u32 s74, s74, 65536
    v_lshl_add_u32 v201, v2, 3, s74
    s_lshl_b32 s74, s73, 6
    s_add_u32 s74, s74, 65536
    v_lshl_add_u32 v205, v3, 4, s74
    s_xor_b32 s73, s3, 2
    s_lshl_b32 s74, s73, 7
    s_add_u32 s74, s74, 65536
    v_lshl_add_u32 v202, v2, 3, s74
    s_lshl_b32 s74, s73, 6
    s_add_u32 s74, s74, 65536
    v_lshl_add_u32 v206, v3, 4, s74
    s_xor_b32 s73, s3, 3
    s_lshl_b32 s74, s73, 7
    s_add_u32 s74, s74, 65536
    v_lshl_add_u32 v203, v2, 3, s74
    s_lshl_b32 s74, s73, 6
    s_add_u32 s74, s74, 65536
    v_lshl_add_u32 v207, v3, 4, s74
    s_lshl_b32 s73, s3, 6
    s_add_u32 s73, s73, 65536
    v_lshl_add_u32 v196, v2, 2, s73
    v_lshl_add_u32 v197, v1, 3, s72
    v_add_u32 v197, 98304, v197
    v_lshlrev_b32 v4, 2, v3
    v_sub_u32 v4, v2, v4
    v_cmp_gt_u32 s[86:87], 4, v4
    s_mov_b32 s94, 0x3b000000
    s_mov_b64 s[48:49], s[40:41]
    s_and_b32 s49, s49, 0xffff
    s_mov_b32 s50, 1409024
    s_mov_b32 s51, 0x20000
    s_mov_b64 s[52:53], s[44:45]
    s_and_b32 s53, s53, 0xffff
    s_mov_b32 s54, 1409024
    s_mov_b32 s55, 0x20000
    s_waitcnt lgkmcnt(0)
    s_add_u32 s70, s70, 1831565813
    s_waitcnt vmcnt(8)
    s_barrier
    ds_read_b64_tr_b16 v[120:121], v14 offset:0
    s_mul_i32 s79, s14, 1536
    ds_read_b64_tr_b16 v[122:123], v14 offset:512
    s_add_u32 m0, s23, 98304
    ds_read_b64_tr_b16 v[124:125], v14 offset:1024
    buffer_load_dwordx4 v11, s[28:31], s79 offen offset:0 lds
    ds_read_b64_tr_b16 v[126:127], v14 offset:1536
    ds_read_b64_tr_b16 v[128:129], v14 offset:8192
    buffer_load_dwordx4 v11, s[28:31], s79 offen offset:1024 lds
    ds_read_b64_tr_b16 v[130:131], v14 offset:8704
    ds_read_b64_tr_b16 v[132:133], v14 offset:9216
    buffer_load_dwordx4 v12, s[28:31], s79 offen offset:2048 lds
    ds_read_b64_tr_b16 v[134:135], v14 offset:9728
    ds_read_b128 a[0:3], v17 offset:0
    buffer_load_dwordx4 v12, s[28:31], s79 offen offset:3072 lds
    ds_read_b128 a[4:7], v18 offset:0
    s_add_u32 m0, s22, 32768
    ds_read_b128 a[8:11], v19 offset:0
    buffer_load_dwordx4 v9, s[24:27], s16 offen  lds
    ds_read_b128 a[12:15], v20 offset:0
    ds_read_b128 a[16:19], v21 offset:0
    buffer_load_dwordx4 v10, s[24:27], s16 offen offset:1024  lds
    ds_read_b128 a[20:23], v22 offset:0
    s_mul_i32 s79, s15, 1536
    ds_read_b128 a[24:27], v23 offset:0
    s_add_u32 m0, s23, 114688
    ds_read_b128 a[28:31], v24 offset:0
    buffer_load_dwordx4 v11, s[28:31], s79 offen offset:0 lds
    ds_read_b128 a[32:35], v17 offset:8192
    ds_read_b128 a[36:39], v18 offset:8192
    buffer_load_dwordx4 v11, s[28:31], s79 offen offset:1024 lds
    ds_read_b128 a[40:43], v19 offset:8192
    ds_read_b128 a[44:47], v20 offset:8192
    buffer_load_dwordx4 v12, s[28:31], s79 offen offset:2048 lds
    ds_read_b128 a[48:51], v21 offset:8192
    ds_read_b128 a[52:55], v22 offset:8192
    buffer_load_dwordx4 v12, s[28:31], s79 offen offset:3072 lds
    ds_read_b128 a[56:59], v23 offset:8192
    ds_read_b128 a[60:63], v24 offset:8192
    s_waitcnt vmcnt(12) lgkmcnt(0)
    s_barrier
    v_mfma_f32_16x16x32_bf16 v[112:115], a[0:3], a[0:3], 0
    ds_read_b64_tr_b16 v[136:137], v14 offset:16384
    s_add_u32 m0, s22, 40960
    s_nop 0
    buffer_load_dwordx4 v9, s[24:27], s17 offen  lds
    v_mfma_f32_16x16x32_bf16 v[116:119], v[32:35], a[0:3], 0
    ds_read_b64_tr_b16 v[138:139], v14 offset:16896
    s_lshl_b32 s73, s67, 7
    v_mfma_f32_16x16x32_bf16 v[112:115], a[16:19], a[16:19], v[112:115]
    ds_read_b64_tr_b16 v[140:141], v14 offset:17408
    buffer_load_dwordx4 v10, s[24:27], s17 offen offset:1024  lds
    v_mfma_f32_16x16x32_bf16 v[116:119], v[32:35], a[16:19], v[116:119]
    ds_read_b64_tr_b16 v[142:143], v14 offset:17920
    s_mul_i32 s79, s16, 1536
    v_mfma_f32_16x16x32_bf16 v[112:115], a[32:35], a[32:35], v[112:115]
    ds_read_b64_tr_b16 v[144:145], v14 offset:24576
    s_add_u32 m0, s23, 131072
    s_nop 0
    buffer_load_dwordx4 v11, s[28:31], s79 offen offset:0 lds
    v_mfma_f32_16x16x32_bf16 v[116:119], v[32:35], a[32:35], v[116:119]
    ds_read_b64_tr_b16 v[146:147], v14 offset:25088
    s_sub_u32 s74, 524288, s73
    v_mfma_f32_16x16x32_bf16 v[112:115], a[48:51], a[48:51], v[112:115]
    ds_read_b64_tr_b16 v[148:149], v14 offset:25600
    buffer_load_dwordx4 v11, s[28:31], s79 offen offset:1024 lds
    v_mfma_f32_16x16x32_bf16 v[116:119], v[32:35], a[48:51], v[116:119]
    ds_read_b64_tr_b16 v[150:151], v14 offset:26112
    v_mfma_f32_16x16x32_bf16 v[52:55], v[120:123], a[0:3], 0
    ds_read_b128 a[64:67], v17 offset:16384
    buffer_load_dwordx4 v12, s[28:31], s79 offen offset:2048 lds
    v_mfma_f32_16x16x32_bf16 v[56:59], v[120:123], a[4:7], 0
    ds_read_b128 a[68:71], v18 offset:16384
    v_mfma_f32_16x16x32_bf16 v[60:63], v[120:123], a[8:11], 0
    ds_read_b128 a[72:75], v19 offset:16384
    buffer_load_dwordx4 v12, s[28:31], s79 offen offset:3072 lds
    v_mfma_f32_16x16x32_bf16 v[64:67], v[120:123], a[12:15], 0
    ds_read_b128 a[76:79], v20 offset:16384
    s_add_u32 m0, s22, 49152
    v_mfma_f32_16x16x32_bf16 v[100:103], v[120:123], v[32:35], 0
    ds_read_b128 a[80:83], v21 offset:16384
    buffer_load_dwordx4 v9, s[24:27], s18 offen  lds
    v_mfma_f32_16x16x32_bf16 v[68:71], a[0:3], v[124:127], 0
    ds_read_b128 a[84:87], v22 offset:16384
    v_mfma_f32_16x16x32_bf16 v[72:75], a[4:7], v[124:127], 0
    ds_read_b128 a[88:91], v23 offset:16384
    buffer_load_dwordx4 v10, s[24:27], s18 offen offset:1024  lds
    v_mfma_f32_16x16x32_bf16 v[76:79], a[8:11], v[124:127], 0
    ds_read_b128 a[92:95], v24 offset:16384
    v_mfma_f32_16x16x32_bf16 v[80:83], a[12:15], v[124:127], 0
    s_add_u32 s36, s36, s73
    s_addc_u32 s37, s37, 0
    v_mfma_f32_16x16x32_bf16 v[104:107], v[32:35], v[124:127], 0
    s_and_b32 s37, s37, 0xffff
    s_mov_b32 s38, s74
    v_mfma_f32_16x16x32_bf16 v[52:55], v[128:131], a[16:19], v[52:55]
    s_mov_b32 s39, 0x20000
    v_lshrrev_b32 v4, 3, v1
    v_mfma_f32_16x16x32_bf16 v[56:59], v[128:131], a[20:23], v[56:59]
    s_lshl_b32 s73, s3, 5
    v_add_u32 v4, s73, v4
    v_mfma_f32_16x16x32_bf16 v[60:63], v[128:131], a[24:27], v[60:63]
    v_lshlrev_b32 v4, 10, v4
    v_bfe_u32 v240, v1, 1, 2
    v_mfma_f32_16x16x32_bf16 v[64:67], v[128:131], a[28:31], v[64:67]
    v_xor_b32 v240, v240, v3
    v_lshl_add_u32 v4, v240, 5, v4
    v_mfma_f32_16x16x32_bf16 v[100:103], v[128:131], v[32:35], v[100:103]
    v_and_b32 v240, 1, v1
    v_lshl_add_u32 v240, v240, 4, v4
    v_mfma_f32_16x16x32_bf16 v[68:71], a[16:19], v[132:135], v[68:71]
    v_add_u32 v241, 7168, v240
    v_add_u32 v242, 14336, v240
    v_mfma_f32_16x16x32_bf16 v[72:75], a[20:23], v[132:135], v[72:75]
    v_add_u32 v243, 21504, v240
    s_mov_b32 s88, 0x3fb8aa3b
    v_mfma_f32_16x16x32_bf16 v[76:79], a[24:27], v[132:135], v[76:79]
    s_mov_b32 s89, 0x3fb8aa3b
    v_mfma_f32_16x16x32_bf16 v[80:83], a[28:31], v[132:135], v[80:83]
    v_mfma_f32_16x16x32_bf16 v[104:107], v[32:35], v[132:135], v[104:107]
    s_waitcnt vmcnt(14) lgkmcnt(0)
    s_barrier
    v_mfma_f32_16x16x32_bf16 v[112:115], a[64:67], a[64:67], v[112:115]
    ds_read_b64_tr_b16 v[120:121], v14 offset:32768
    ds_read_b64_tr_b16 v[122:123], v14 offset:33280
    v_mfma_f32_16x16x32_bf16 v[116:119], v[32:35], a[64:67], v[116:119]
    ds_read_b64_tr_b16 v[124:125], v14 offset:33792
    s_mul_i32 s79, s17, 1536
    v_mfma_f32_16x16x32_bf16 v[112:115], a[80:83], a[80:83], v[112:115]
    ds_read_b64_tr_b16 v[126:127], v14 offset:34304
    s_add_u32 m0, s23, 147456
    s_nop 0
    buffer_load_dwordx4 v11, s[28:31], s79 offen offset:0 lds
    v_mfma_f32_16x16x32_bf16 v[116:119], v[32:35], a[80:83], v[116:119]
    ds_read_b64_tr_b16 v[128:129], v14 offset:40960
    v_mfma_f32_16x16x32_bf16 v[52:55], v[136:139], a[32:35], v[52:55]
    ds_read_b64_tr_b16 v[130:131], v14 offset:41472
    buffer_load_dwordx4 v11, s[28:31], s79 offen offset:1024 lds
    v_mfma_f32_16x16x32_bf16 v[56:59], v[136:139], a[36:39], v[56:59]
    ds_read_b64_tr_b16 v[132:133], v14 offset:41984
    v_mfma_f32_16x16x32_bf16 v[60:63], v[136:139], a[40:43], v[60:63]
    ds_read_b64_tr_b16 v[134:135], v14 offset:42496
    buffer_load_dwordx4 v12, s[28:31], s79 offen offset:2048 lds
    v_mfma_f32_16x16x32_bf16 v[64:67], v[136:139], a[44:47], v[64:67]
    ds_read_b128 a[96:99], v17 offset:24576
    ds_read_b128 a[100:103], v18 offset:24576
    v_mfma_f32_16x16x32_bf16 v[100:103], v[136:139], v[32:35], v[100:103]
    ds_read_b128 a[104:107], v19 offset:24576
    buffer_load_dwordx4 v12, s[28:31], s79 offen offset:3072 lds
    v_mfma_f32_16x16x32_bf16 v[68:71], a[32:35], v[140:143], v[68:71]
    ds_read_b128 a[108:111], v20 offset:24576
    s_add_u32 m0, s22, 57344
    v_mfma_f32_16x16x32_bf16 v[72:75], a[36:39], v[140:143], v[72:75]
    ds_read_b128 a[112:115], v21 offset:24576
    buffer_load_dwordx4 v9, s[24:27], s19 offen  lds
    v_mfma_f32_16x16x32_bf16 v[76:79], a[40:43], v[140:143], v[76:79]
    ds_read_b128 a[116:119], v22 offset:24576
    v_mfma_f32_16x16x32_bf16 v[80:83], a[44:47], v[140:143], v[80:83]
    ds_read_b128 a[120:123], v23 offset:24576
    buffer_load_dwordx4 v10, s[24:27], s19 offen offset:1024  lds
    v_mfma_f32_16x16x32_bf16 v[104:107], v[32:35], v[140:143], v[104:107]
    ds_read_b128 a[124:127], v24 offset:24576
    v_mfma_f32_16x16x32_bf16 v[52:55], v[144:147], a[48:51], v[52:55]
    s_cmp_ge_u32 s65, 15
    s_cselect_b32 s73, 1, 0
    v_mfma_f32_16x16x32_bf16 v[56:59], v[144:147], a[52:55], v[56:59]
    s_mul_i32 s74, s73, 15
    s_sub_u32 s91, s65, s74
    v_mfma_f32_16x16x32_bf16 v[60:63], v[144:147], a[56:59], v[60:63]
    s_lshl_b32 s74, s64, 1
    s_add_u32 s73, s73, s74
    v_mfma_f32_16x16x32_bf16 v[64:67], v[144:147], a[60:63], v[64:67]
    s_lshl_b32 s73, s73, 2
    s_add_u32 s90, s73, s3
    v_mfma_f32_16x16x32_bf16 v[100:103], v[144:147], v[32:35], v[100:103]
    s_min_u32 s91, s91, 14
    s_mul_i32 s73, s91, 192
    v_mfma_f32_16x16x32_bf16 v[68:71], a[48:51], v[148:151], v[68:71]
    s_sub_u32 s74, 2752, s73
    v_mfma_f32_16x16x32_bf16 v[72:75], a[52:55], v[148:151], v[72:75]
    s_add_u32 s4, s4, s73
    s_addc_u32 s5, s5, 0
    v_mfma_f32_16x16x32_bf16 v[76:79], a[56:59], v[148:151], v[76:79]
    s_and_b32 s5, s5, 0xffff
    s_mov_b32 s6, s74
    v_mfma_f32_16x16x32_bf16 v[80:83], a[60:63], v[148:151], v[80:83]
    s_mov_b32 s7, 0x20000
    s_sub_u32 s74, 1409024, s73
    v_mfma_f32_16x16x32_bf16 v[104:107], v[32:35], v[148:151], v[104:107]
    s_add_u32 s40, s40, s73
    s_addc_u32 s41, s41, 0
    s_and_b32 s41, s41, 0xffff
    s_mov_b32 s42, s74
    s_mov_b32 s43, 0x20000
    s_waitcnt vmcnt(14) lgkmcnt(0)
    s_barrier
    v_mfma_f32_16x16x32_bf16 v[112:115], a[96:99], a[96:99], v[112:115]
    ds_read_b64_tr_b16 v[136:137], v14 offset:49152
    ds_read_b64_tr_b16 v[138:139], v14 offset:49664
    v_mfma_f32_16x16x32_bf16 v[116:119], v[32:35], a[96:99], v[116:119]
    ds_read_b64_tr_b16 v[140:141], v14 offset:50176
    s_mul_i32 s79, s18, 1536
    v_mfma_f32_16x16x32_bf16 v[112:115], a[112:115], a[112:115], v[112:115]
    ds_read_b64_tr_b16 v[142:143], v14 offset:50688
    s_add_u32 m0, s23, 65536
    s_nop 0
    buffer_load_dwordx4 v11, s[28:31], s79 offen offset:0 lds
    v_mfma_f32_16x16x32_bf16 v[116:119], v[32:35], a[112:115], v[116:119]
    ds_read_b64_tr_b16 v[144:145], v14 offset:57344
    s_and_b32 s9, s9, 0xffff
    v_mfma_f32_16x16x32_bf16 v[52:55], v[120:123], a[64:67], v[52:55]
    ds_read_b64_tr_b16 v[146:147], v14 offset:57856
    buffer_load_dwordx4 v11, s[28:31], s79 offen offset:1024 lds
    v_mfma_f32_16x16x32_bf16 v[56:59], v[120:123], a[68:71], v[56:59]
    ds_read_b64_tr_b16 v[148:149], v14 offset:58368
    s_mov_b32 s10, 1024
    v_mfma_f32_16x16x32_bf16 v[60:63], v[120:123], a[72:75], v[60:63]
    ds_read_b64_tr_b16 v[150:151], v14 offset:58880
    buffer_load_dwordx4 v12, s[28:31], s79 offen offset:2048 lds
    v_mfma_f32_16x16x32_bf16 v[64:67], v[120:123], a[76:79], v[64:67]
    ds_read_b128 a[128:131], v17 offset:32768
    ds_read_b128 a[132:135], v18 offset:32768
    v_mfma_f32_16x16x32_bf16 v[100:103], v[120:123], v[32:35], v[100:103]
    ds_read_b128 a[136:139], v19 offset:32768
    buffer_load_dwordx4 v12, s[28:31], s79 offen offset:3072 lds
    v_mfma_f32_16x16x32_bf16 v[68:71], a[64:67], v[124:127], v[68:71]
    ds_read_b128 a[140:143], v20 offset:32768
    s_mul_i32 s79, s19, 1536
    v_mfma_f32_16x16x32_bf16 v[72:75], a[68:71], v[124:127], v[72:75]
    ds_read_b128 a[144:147], v21 offset:32768
    s_add_u32 m0, s23, 81920
    s_nop 0
    buffer_load_dwordx4 v11, s[28:31], s79 offen offset:0 lds
    v_mfma_f32_16x16x32_bf16 v[76:79], a[72:75], v[124:127], v[76:79]
    ds_read_b128 a[148:151], v22 offset:32768
    s_mov_b32 s11, 0x20000
    v_mfma_f32_16x16x32_bf16 v[80:83], a[76:79], v[124:127], v[80:83]
    ds_read_b128 a[152:155], v23 offset:32768
    buffer_load_dwordx4 v11, s[28:31], s79 offen offset:1024 lds
    v_mfma_f32_16x16x32_bf16 v[104:107], v[32:35], v[124:127], v[104:107]
    ds_read_b128 a[156:159], v24 offset:32768
    s_mul_i32 s95, s3, 3072
    v_mfma_f32_16x16x32_bf16 v[52:55], v[128:131], a[80:83], v[52:55]
    buffer_load_dwordx4 v12, s[28:31], s79 offen offset:2048 lds
    s_lshl_b32 s73, s67, 7
    v_mfma_f32_16x16x32_bf16 v[56:59], v[128:131], a[84:87], v[56:59]
    s_sub_u32 s73, s73, s12
    s_and_b32 s73, s73, 0x380
    v_mfma_f32_16x16x32_bf16 v[60:63], v[128:131], a[88:91], v[60:63]
    buffer_load_dwordx4 v12, s[28:31], s79 offen offset:3072 lds
    s_lshl_b32 s73, s73, 6
    v_mfma_f32_16x16x32_bf16 v[64:67], v[128:131], a[92:95], v[64:67]
    s_add_u32 s73, s73, s22
    v_lshrrev_b32 v88, 1, v2
    v_mfma_f32_16x16x32_bf16 v[100:103], v[128:131], v[32:35], v[100:103]
    v_lshrrev_b32 v4, 1, v3
    v_xor_b32 v88, v4, v88
    v_mfma_f32_16x16x32_bf16 v[68:71], a[80:83], v[132:135], v[68:71]
    v_lshlrev_b32 v88, 4, v88
    v_lshl_add_u32 v88, v2, 7, v88
    v_mfma_f32_16x16x32_bf16 v[72:75], a[84:87], v[132:135], v[72:75]
    v_lshl_add_u32 v88, v7, 3, v88
    v_add_u32 v88, s73, v88
    v_mfma_f32_16x16x32_bf16 v[76:79], a[88:91], v[132:135], v[76:79]
    v_xor_b32 v93, 32, v88
    v_xor_b32 v94, 64, v88
    v_mfma_f32_16x16x32_bf16 v[80:83], a[92:95], v[132:135], v[80:83]
    v_xor_b32 v95, 96, v88
    v_mfma_f32_16x16x32_bf16 v[104:107], v[32:35], v[132:135], v[104:107]
    s_waitcnt vmcnt(16) lgkmcnt(0)
    s_barrier
    v_mfma_f32_16x16x32_bf16 v[112:115], a[128:131], a[128:131], v[112:115]
    ds_read_b64_tr_b16 v[120:121], v15 offset:0
    ds_read_b64_tr_b16 v[122:123], v15 offset:512
    v_mfma_f32_16x16x32_bf16 v[116:119], v[32:35], a[128:131], v[116:119]
    ds_read_b64_tr_b16 v[124:125], v15 offset:1024
    v_mov_b32 v252, s70
    v_mfma_f32_16x16x32_bf16 v[112:115], a[144:147], a[144:147], v[112:115]
    ds_read_b64_tr_b16 v[126:127], v15 offset:1536
    v_mov_b32 v253, s71
    v_mfma_f32_16x16x32_bf16 v[116:119], v[32:35], a[144:147], v[116:119]
    ds_read_b64_tr_b16 v[128:129], v15 offset:8192
    v_mov_b32 v254, v252
    v_mfma_f32_16x16x32_bf16 v[52:55], v[136:139], a[96:99], v[52:55]
    ds_read_b64_tr_b16 v[130:131], v15 offset:8704
    v_mov_b32 v255, v253
    v_mfma_f32_16x16x32_bf16 v[56:59], v[136:139], a[100:103], v[56:59]
    ds_read_b64_tr_b16 v[132:133], v15 offset:9216
    s_lshl_b32 s77, s2, 7
    v_mfma_f32_16x16x32_bf16 v[60:63], v[136:139], a[104:107], v[60:63]
    ds_read_b64_tr_b16 v[134:135], v15 offset:9728
    s_add_u32 s77, s77, 65536
    v_mfma_f32_16x16x32_bf16 v[64:67], v[136:139], a[108:111], v[64:67]
    ds_read_b128 a[160:163], v17 offset:40960
    ds_read_b128 a[164:167], v18 offset:40960
    v_mfma_f32_16x16x32_bf16 v[100:103], v[136:139], v[32:35], v[100:103]
    ds_read_b128 a[168:171], v19 offset:40960
    v_add_u32 v251, s72, v1
    v_mfma_f32_16x16x32_bf16 v[68:71], a[96:99], v[140:143], v[68:71]
    ds_read_b128 a[172:175], v20 offset:40960
    v_lshrrev_b32 v251, 3, v251
    v_mfma_f32_16x16x32_bf16 v[72:75], a[100:103], v[140:143], v[72:75]
    ds_read_b128 a[176:179], v21 offset:40960
    v_min_u32 v251, 1, v251
    v_mfma_f32_16x16x32_bf16 v[76:79], a[104:107], v[140:143], v[76:79]
    ds_read_b128 a[180:183], v22 offset:40960
    v_lshlrev_b32 v251, 30, v251
    v_mfma_f32_16x16x32_bf16 v[80:83], a[108:111], v[140:143], v[80:83]
    ds_read_b128 a[184:187], v23 offset:40960
    v_add_u32 v251, v251, v8
    buffer_store_dwordx4 v[252:255], v251, s[32:35], s77 offen sc1
    v_mfma_f32_16x16x32_bf16 v[104:107], v[32:35], v[140:143], v[104:107]
    ds_read_b128 a[188:191], v24 offset:40960
    s_lshl_b32 s13, s68, 17
    v_mfma_f32_16x16x32_bf16 v[52:55], v[144:147], a[112:115], v[52:55]
    s_lshl_b32 s14, s68, 14
    s_or_b32 s14, s14, s23
    v_mfma_f32_16x16x32_bf16 v[56:59], v[144:147], a[116:119], v[56:59]
    s_cmp_ge_u32 s65, 15
    s_cselect_b32 s15, 704512, 0
    v_mfma_f32_16x16x32_bf16 v[60:63], v[144:147], a[120:123], v[60:63]
    s_lshl_b32 s77, s69, 9
    s_add_u32 m0, s72, 98304
    v_mfma_f32_16x16x32_bf16 v[64:67], v[144:147], a[124:127], v[64:67]
    s_lshl_b32 s73, s68, 3
    s_mul_i32 s16, s3, 22
    v_mfma_f32_16x16x32_bf16 v[100:103], v[144:147], v[32:35], v[100:103]
    buffer_load_dwordx4 v8, s[60:63], s77 offen lds
    s_lshr_b32 s73, 302908928, s73
    v_mfma_f32_16x16x32_bf16 v[68:71], a[112:115], v[148:151], v[68:71]
    s_and_b32 s73, s73, 0xff
    s_add_u32 s16, s16, s73
    v_mfma_f32_16x16x32_bf16 v[72:75], a[116:119], v[148:151], v[72:75]
    s_lshl_b32 s19, s16, 14
    s_lshl_b32 s16, s16, 10
    v_mfma_f32_16x16x32_bf16 v[76:79], a[120:123], v[148:151], v[76:79]
    v_mfma_f32_16x16x32_bf16 v[80:83], a[124:127], v[148:151], v[80:83]
    s_lshl_b32 s77, s66, 2
    s_add_u32 s77, s77, s3
    v_mfma_f32_16x16x32_bf16 v[104:107], v[32:35], v[148:151], v[104:107]
    s_lshl_b32 s77, s77, 12
    v_min_u32 v248, 3, v1
    v_lshlrev_b32 v248, 10, v248
    buffer_load_dword v90, v248, s[36:39], s77 offen
    s_lshl_b32 s77, s65, 2
    s_add_u32 s77, s77, s3
    s_lshl_b32 s77, s77, 12
    s_add_u32 s77, s77, 1408
    s_lshl_b32 s75, s67, 7
    s_sub_u32 s77, s77, s75
    v_add_u32 v247, -1024, v248
    buffer_load_dword v90, v247, s[36:39], s77 offen
    s_waitcnt vmcnt(14) lgkmcnt(0)
    s_barrier
    v_mfma_f32_16x16x32_bf16 v[112:115], a[160:163], a[160:163], v[112:115]
    ds_read_b64_tr_b16 v[136:137], v15 offset:16384
    ds_read_b64_tr_b16 v[138:139], v15 offset:16896
    v_mfma_f32_16x16x32_bf16 v[116:119], v[32:35], a[160:163], v[116:119]
    ds_read_b64_tr_b16 v[140:141], v15 offset:17408
    v_mfma_f32_16x16x32_bf16 v[112:115], a[176:179], a[176:179], v[112:115]
    ds_read_b64_tr_b16 v[142:143], v15 offset:17920
    v_mfma_f32_16x16x32_bf16 v[116:119], v[32:35], a[176:179], v[116:119]
    ds_read_b64_tr_b16 v[144:145], v15 offset:24576
    s_lshl_b32 s77, s2, 2
    v_mfma_f32_16x16x32_bf16 v[52:55], v[120:123], a[128:131], v[52:55]
    ds_read_b64_tr_b16 v[146:147], v15 offset:25088
    s_add_u32 s77, s77, s3
    v_mfma_f32_16x16x32_bf16 v[56:59], v[120:123], a[132:135], v[56:59]
    ds_read_b64_tr_b16 v[148:149], v15 offset:25600
    s_mul_i32 s77, s77, 1408
    v_mfma_f32_16x16x32_bf16 v[60:63], v[120:123], a[136:139], v[60:63]
    ds_read_b64_tr_b16 v[150:151], v15 offset:26112
    v_min_u32 v248, 10, v1
    v_mfma_f32_16x16x32_bf16 v[64:67], v[120:123], a[140:143], v[64:67]
    ds_read_b128 a[192:195], v17 offset:49152
    ds_read_b128 a[196:199], v18 offset:49152
    v_mfma_f32_16x16x32_bf16 v[100:103], v[120:123], v[32:35], v[100:103]
    ds_read_b128 a[200:203], v19 offset:49152
    v_lshlrev_b32 v248, 7, v248
    buffer_load_dword v90, v248, s[48:51], s77 offen
    v_mfma_f32_16x16x32_bf16 v[68:71], a[128:131], v[124:127], v[68:71]
    ds_read_b128 a[204:207], v20 offset:49152
    v_mfma_f32_16x16x32_bf16 v[72:75], a[132:135], v[124:127], v[72:75]
    ds_read_b128 a[208:211], v21 offset:49152
    v_mfma_f32_16x16x32_bf16 v[76:79], a[136:139], v[124:127], v[76:79]
    ds_read_b128 a[212:215], v22 offset:49152
    v_mfma_f32_16x16x32_bf16 v[80:83], a[140:143], v[124:127], v[80:83]
    ds_read_b128 a[216:219], v23 offset:49152
    v_mfma_f32_16x16x32_bf16 v[104:107], v[32:35], v[124:127], v[104:107]
    ds_read_b128 a[220:223], v24 offset:49152
    v_mfma_f32_16x16x32_bf16 v[52:55], v[128:131], a[144:147], v[52:55]
    buffer_load_dword v90, v248, s[52:55], s77 offen
    v_mfma_f32_16x16x32_bf16 v[56:59], v[128:131], a[148:151], v[56:59]
    v_mfma_f32_16x16x32_bf16 v[60:63], v[128:131], a[152:155], v[60:63]
    v_mfma_f32_16x16x32_bf16 v[64:67], v[128:131], a[156:159], v[64:67]
    v_mfma_f32_16x16x32_bf16 v[100:103], v[128:131], v[32:35], v[100:103]
    s_lshl_b32 s77, s67, 7
    v_lshlrev_b32 v249, 4, v6
    v_mfma_f32_16x16x32_bf16 v[68:71], a[144:147], v[132:135], v[68:71]
    v_lshl_add_u32 v249, v7, 5, v249
    v_mfma_f32_16x16x32_bf16 v[72:75], a[148:151], v[132:135], v[72:75]
    buffer_load_dwordx4 v[44:47], v249, s[8:11], s77 offen offset:0
    v_mfma_f32_16x16x32_bf16 v[76:79], a[152:155], v[132:135], v[76:79]
    v_mfma_f32_16x16x32_bf16 v[80:83], a[156:159], v[132:135], v[80:83]
    v_mfma_f32_16x16x32_bf16 v[104:107], v[32:35], v[132:135], v[104:107]
    buffer_load_dwordx4 v[48:51], v249, s[8:11], s77 offen offset:64
    v_lshlrev_b32 v250, 1, v5
    buffer_load_ushort v25, v250, s[4:7], 0 offen offset:0
    buffer_load_ushort v26, v250, s[4:7], 0 offen offset:64
    buffer_load_ushort v27, v250, s[4:7], 0 offen offset:128
    s_waitcnt vmcnt(15) lgkmcnt(0)
    s_barrier
    v_mfma_f32_16x16x32_bf16 v[112:115], a[192:195], a[192:195], v[112:115]
    ds_read_b64_tr_b16 v[120:121], v14 offset:0
    ds_read_b64_tr_b16 v[122:123], v14 offset:512
    v_mfma_f32_16x16x32_bf16 v[116:119], v[32:35], a[192:195], v[116:119]
    ds_read_b64_tr_b16 v[124:125], v14 offset:1024
    s_lshl_b32 s73, s64, 3
    v_mfma_f32_16x16x32_bf16 v[112:115], a[208:211], a[208:211], v[112:115]
    ds_read_b64_tr_b16 v[126:127], v14 offset:1536
    s_mul_i32 s74, s3, 12288
    v_mfma_f32_16x16x32_bf16 v[116:119], v[32:35], a[208:211], v[116:119]
    ds_read_b64_tr_b16 v[128:129], v14 offset:8192
    s_add_u32 s79, s12, 128
    v_mfma_f32_16x16x32_bf16 v[52:55], v[136:139], a[160:163], v[52:55]
    ds_read_b64_tr_b16 v[130:131], v14 offset:8704
    s_and_b32 s79, s79, 0x380
    v_mfma_f32_16x16x32_bf16 v[56:59], v[136:139], a[164:167], v[56:59]
    ds_read_b64_tr_b16 v[132:133], v14 offset:9216
    s_mul_i32 s79, s79, 1536
    v_mfma_f32_16x16x32_bf16 v[60:63], v[136:139], a[168:171], v[60:63]
    ds_read_b64_tr_b16 v[134:135], v14 offset:9728
    s_add_u32 m0, s22, 106496
    s_nop 0
    buffer_load_dwordx4 v13, s[28:31], s79 offen lds
    v_mfma_f32_16x16x32_bf16 v[64:67], v[136:139], a[172:175], v[64:67]
    ds_read_b128 a[224:227], v17 offset:57344
    ds_read_b128 a[228:231], v18 offset:57344
    v_mfma_f32_16x16x32_bf16 v[100:103], v[136:139], v[32:35], v[100:103]
    ds_read_b128 a[232:235], v19 offset:57344
    s_add_u32 s73, s73, s67
    v_mfma_f32_16x16x32_bf16 v[68:71], a[160:163], v[140:143], v[68:71]
    ds_read_b128 a[236:239], v20 offset:57344
    s_mul_i32 s18, s68, 3072
    v_mfma_f32_16x16x32_bf16 v[72:75], a[164:167], v[140:143], v[72:75]
    ds_read_b128 a[240:243], v21 offset:57344
    s_mul_i32 s17, s73, 88064
    v_mfma_f32_16x16x32_bf16 v[76:79], a[168:171], v[140:143], v[76:79]
    ds_read_b128 a[244:247], v22 offset:57344
    s_add_u32 s74, s74, 10518528
    v_mfma_f32_16x16x32_bf16 v[80:83], a[172:175], v[140:143], v[80:83]
    ds_read_b128 a[248:251], v23 offset:57344
    buffer_load_dwordx4 v12, s[28:31], s79 offen offset:1024 lds
    v_mfma_f32_16x16x32_bf16 v[104:107], v[32:35], v[140:143], v[104:107]
    ds_read_b128 a[252:255], v24 offset:57344
    s_add_u32 s17, s17, s74
    v_mfma_f32_16x16x32_bf16 v[52:55], v[144:147], a[176:179], v[52:55]
    s_add_u32 s18, s18, s17
    v_add_u32 v9, 0, v244
    v_mfma_f32_16x16x32_bf16 v[56:59], v[144:147], a[180:183], v[56:59]
    v_add_u32 v10, -1024, v245
    v_add_u32 v11, -2048, v246
    v_mfma_f32_16x16x32_bf16 v[60:63], v[144:147], a[184:187], v[60:63]
    s_add_u32 s79, s12, 256
    s_and_b32 s79, s79, 0x380
    v_mfma_f32_16x16x32_bf16 v[64:67], v[144:147], a[188:191], v[64:67]
    s_mul_i32 s79, s79, 1536
    s_add_u32 m0, s22, 114688
    v_mfma_f32_16x16x32_bf16 v[100:103], v[144:147], v[32:35], v[100:103]
    buffer_load_dwordx4 v13, s[28:31], s79 offen lds
    v_mfma_f32_16x16x32_bf16 v[68:71], a[176:179], v[148:151], v[68:71]
    v_mfma_f32_16x16x32_bf16 v[72:75], a[180:183], v[148:151], v[72:75]
    v_mfma_f32_16x16x32_bf16 v[76:79], a[184:187], v[148:151], v[76:79]
    v_mfma_f32_16x16x32_bf16 v[80:83], a[188:191], v[148:151], v[80:83]
    v_mfma_f32_16x16x32_bf16 v[104:107], v[32:35], v[148:151], v[104:107]
    buffer_load_dwordx4 v12, s[28:31], s79 offen offset:1024 lds
    s_waitcnt vmcnt(15) lgkmcnt(0)
    s_barrier
    v_mfma_f32_16x16x32_bf16 v[112:115], a[224:227], a[224:227], v[112:115]
    ds_read_b64_tr_b16 v[136:137], v14 offset:16384
    v_mfma_f32_16x16x32_bf16 v[116:119], v[32:35], a[224:227], v[116:119]
    ds_read_b64_tr_b16 v[138:139], v14 offset:16896
    v_mfma_f32_16x16x32_bf16 v[112:115], a[240:243], a[240:243], v[112:115]
    ds_read_b64_tr_b16 v[140:141], v14 offset:17408
    v_mfma_f32_16x16x32_bf16 v[116:119], v[32:35], a[240:243], v[116:119]
    ds_read_b64_tr_b16 v[142:143], v14 offset:17920
    s_add_u32 s79, s12, 384
    v_mfma_f32_16x16x32_bf16 v[52:55], v[120:123], a[192:195], v[52:55]
    ds_read_b64_tr_b16 v[144:145], v14 offset:24576
    s_and_b32 s79, s79, 0x380
    v_mfma_f32_16x16x32_bf16 v[56:59], v[120:123], a[196:199], v[56:59]
    ds_read_b64_tr_b16 v[146:147], v14 offset:25088
    s_mul_i32 s79, s79, 1536
    v_mfma_f32_16x16x32_bf16 v[60:63], v[120:123], a[200:203], v[60:63]
    s_add_u32 m0, s22, 122880
    s_nop 0
    buffer_load_dwordx4 v13, s[28:31], s79 offen lds
    v_mfma_f32_16x16x32_bf16 v[64:67], v[120:123], a[204:207], v[64:67]
    ds_read_b64_tr_b16 v[148:149], v14 offset:25600
    v_mfma_f32_16x16x32_bf16 v[100:103], v[120:123], v[32:35], v[100:103]
    ds_read_b64_tr_b16 v[150:151], v14 offset:26112
    v_cndmask_b32 v192, v112, v113, s[80:81]
    v_mfma_f32_16x16x32_bf16 v[68:71], a[192:195], v[124:127], v[68:71]
    ds_read_b64 v[36:37], v88
    v_cndmask_b32 v192, v192, v114, s[82:83]
    v_mfma_f32_16x16x32_bf16 v[72:75], a[196:199], v[124:127], v[72:75]
    ds_read_b64 v[38:39], v93
    v_cndmask_b32 v192, v192, v115, s[84:85]
    v_mfma_f32_16x16x32_bf16 v[76:79], a[200:203], v[124:127], v[76:79]
    ds_read_b64 v[40:41], v94
    v_mul_f32 v193, s94, v116
    v_mfma_f32_16x16x32_bf16 v[80:83], a[204:207], v[124:127], v[80:83]
    ds_read_b64 v[42:43], v95
    buffer_load_dwordx4 v12, s[28:31], s79 offen offset:1024 lds
    v_mfma_f32_16x16x32_bf16 v[104:107], v[32:35], v[124:127], v[104:107]
    v_mul_f32 v194, v193, v193
    v_fma_f32 v192, v192, s94, -v194
    v_mfma_f32_16x16x32_bf16 v[52:55], v[128:131], a[208:211], v[52:55]
    v_max_f32 v192, 0, v192
    v_add_f32 v192, 0x3727c5ac, v192
    v_mfma_f32_16x16x32_bf16 v[56:59], v[128:131], a[212:215], v[56:59]
    v_rsq_f32 v192, v192
    v_mfma_f32_16x16x32_bf16 v[60:63], v[128:131], a[216:219], v[60:63]
    s_add_u32 s79, s12, 512
    s_and_b32 s79, s79, 0x380
    v_mfma_f32_16x16x32_bf16 v[64:67], v[128:131], a[220:223], v[64:67]
    s_mul_i32 s79, s79, 1536
    s_add_u32 m0, s22, 131072
    v_mfma_f32_16x16x32_bf16 v[100:103], v[128:131], v[32:35], v[100:103]
    buffer_load_dwordx4 v13, s[28:31], s79 offen lds
    v_mul_f32 v193, v193, v192
    v_mfma_f32_16x16x32_bf16 v[68:71], a[208:211], v[132:135], v[68:71]
    v_sub_f32 v193, 0, v193
    v_mfma_f32_16x16x32_bf16 v[72:75], a[212:215], v[132:135], v[72:75]
    v_mfma_f32_16x16x32_bf16 v[76:79], a[216:219], v[132:135], v[76:79]
    v_mfma_f32_16x16x32_bf16 v[80:83], a[220:223], v[132:135], v[80:83]
    v_mfma_f32_16x16x32_bf16 v[104:107], v[32:35], v[132:135], v[104:107]
    buffer_load_dwordx4 v12, s[28:31], s79 offen offset:1024 lds
    s_mov_b64 exec, s[86:87]
    ds_write_b64 v200, v[192:193]
    ds_write_b32 v196, v192 offset:512
    ds_write_b32 v196, v193 offset:768
    s_mov_b64 exec, -1
    s_waitcnt vmcnt(17) lgkmcnt(0)
    s_barrier
    v_mfma_f32_16x16x32_bf16 v[52:55], v[136:139], a[224:227], v[52:55]
    ds_read_b64 v[152:153], v200
    ds_read_b64 v[154:155], v201
    v_mfma_f32_16x16x32_bf16 v[56:59], v[136:139], a[228:231], v[56:59]
    ds_read_b64 v[156:157], v202
    v_lshlrev_b32 v4, 2, v3
    v_mfma_f32_16x16x32_bf16 v[60:63], v[136:139], a[232:235], v[60:63]
    ds_read_b64 v[158:159], v203
    v_sub_u32 v4, v2, v4
    v_mfma_f32_16x16x32_bf16 v[64:67], v[136:139], a[236:239], v[64:67]
    ds_read_b128 v[160:163], v204 offset:512
    s_add_u32 s79, s12, 640
    v_mfma_f32_16x16x32_bf16 v[100:103], v[136:139], v[32:35], v[100:103]
    ds_read_b128 v[176:179], v204 offset:768
    s_and_b32 s79, s79, 0x380
    v_mfma_f32_16x16x32_bf16 v[68:71], a[224:227], v[140:143], v[68:71]
    ds_read_b128 v[164:167], v205 offset:512
    s_mul_i32 s79, s79, 1536
    v_mfma_f32_16x16x32_bf16 v[72:75], a[228:231], v[140:143], v[72:75]
    ds_read_b128 v[180:183], v205 offset:768
    s_add_u32 m0, s22, 139264
    s_nop 0
    buffer_load_dwordx4 v13, s[28:31], s79 offen lds
    v_mfma_f32_16x16x32_bf16 v[76:79], a[232:235], v[140:143], v[76:79]
    ds_read_b128 v[168:171], v206 offset:512
    v_mov_b32 v192, 0x3f80
    v_mfma_f32_16x16x32_bf16 v[80:83], a[236:239], v[140:143], v[80:83]
    ds_read_b128 v[184:187], v206 offset:768
    v_mov_b32 v193, 0x3f800000
    v_mfma_f32_16x16x32_bf16 v[104:107], v[32:35], v[140:143], v[104:107]
    ds_read_b128 v[172:175], v207 offset:512
    v_cmp_eq_u32 vcc, 0, v4
    v_mfma_f32_16x16x32_bf16 v[52:55], v[144:147], a[240:243], v[52:55]
    ds_read_b128 v[188:191], v207 offset:768
    v_cmp_eq_u32 s[80:81], 1, v4
    v_mfma_f32_16x16x32_bf16 v[56:59], v[144:147], a[244:247], v[56:59]
    ds_read_b64_tr_b16 v[28:29], v197
    v_cmp_eq_u32 s[82:83], 2, v4
    v_mfma_f32_16x16x32_bf16 v[60:63], v[144:147], a[248:251], v[60:63]
    buffer_load_dwordx4 v12, s[28:31], s79 offen offset:1024 lds
    v_cmp_eq_u32 s[84:85], 3, v4
    v_mfma_f32_16x16x32_bf16 v[64:67], v[144:147], a[252:255], v[64:67]
    v_cndmask_b32 v30, 0, v192, vcc
    v_cndmask_b32 v31, 0, v192, s[82:83]
    v_mfma_f32_16x16x32_bf16 v[100:103], v[144:147], v[32:35], v[100:103]
    v_cndmask_b32 v30, v30, v193, s[80:81]
    v_cndmask_b32 v31, v31, v193, s[84:85]
    v_mfma_f32_16x16x32_bf16 v[68:71], a[240:243], v[148:151], v[68:71]
    v_mfma_f32_16x16x32_bf16 v[72:75], a[244:247], v[148:151], v[72:75]
    s_add_u32 s79, s12, 768
    s_and_b32 s79, s79, 0x380
    v_mfma_f32_16x16x32_bf16 v[76:79], a[248:251], v[148:151], v[76:79]
    s_mul_i32 s79, s79, 1536
    s_add_u32 m0, s22, 147456
    v_mfma_f32_16x16x32_bf16 v[80:83], a[252:255], v[148:151], v[80:83]
    buffer_load_dwordx4 v13, s[28:31], s79 offen lds
    v_mfma_f32_16x16x32_bf16 v[104:107], v[32:35], v[148:151], v[104:107]
    buffer_load_dwordx4 v12, s[28:31], s79 offen offset:1024 lds
    s_waitcnt lgkmcnt(0)
    s_barrier
    v_pk_mul_f32 v[200:201], v[100:101], v[152:153] op_sel:[0,1] op_sel_hi:[1,1]
    v_pk_mul_f32 v[202:203], v[102:103], v[152:153] op_sel:[0,1] op_sel_hi:[1,1]
    v_pk_fma_f32 v[200:201], v[52:53], v[152:153], v[200:201] op_sel_hi:[1,0,1]
    v_pk_fma_f32 v[202:203], v[54:55], v[152:153], v[202:203] op_sel_hi:[1,0,1]
    v_cvt_pk_bf16_f32 v192, v200, v201
    v_cvt_pk_bf16_f32 v193, v202, v203
    v_pk_mul_f32 v[204:205], v[100:101], v[154:155] op_sel:[0,1] op_sel_hi:[1,1]
    v_pk_mul_f32 v[206:207], v[102:103], v[154:155] op_sel:[0,1] op_sel_hi:[1,1]
    v_pk_fma_f32 v[204:205], v[56:57], v[154:155], v[204:205] op_sel_hi:[1,0,1]
    v_pk_fma_f32 v[206:207], v[58:59], v[154:155], v[206:207] op_sel_hi:[1,0,1]
    s_add_u32 s79, s12, 896
    v_cvt_pk_bf16_f32 v194, v204, v205
    s_and_b32 s79, s79, 0x380
    v_cvt_pk_bf16_f32 v195, v206, v207
    s_mul_i32 s79, s79, 1536
    v_pk_mul_f32 v[200:201], v[100:101], v[156:157] op_sel:[0,1] op_sel_hi:[1,1]
    s_add_u32 m0, s22, 155648
    v_pk_mul_f32 v[202:203], v[102:103], v[156:157] op_sel:[0,1] op_sel_hi:[1,1]
    buffer_load_dwordx4 v13, s[28:31], s79 offen lds
    v_pk_fma_f32 v[200:201], v[60:61], v[156:157], v[200:201] op_sel_hi:[1,0,1]
    v_pk_fma_f32 v[202:203], v[62:63], v[156:157], v[202:203] op_sel_hi:[1,0,1]
    v_cvt_pk_bf16_f32 v196, v200, v201
    v_cvt_pk_bf16_f32 v197, v202, v203
    v_pk_mul_f32 v[204:205], v[100:101], v[158:159] op_sel:[0,1] op_sel_hi:[1,1]
    v_pk_mul_f32 v[206:207], v[102:103], v[158:159] op_sel:[0,1] op_sel_hi:[1,1]
    v_pk_fma_f32 v[204:205], v[64:65], v[158:159], v[204:205] op_sel_hi:[1,0,1]
    v_pk_fma_f32 v[206:207], v[66:67], v[158:159], v[206:207] op_sel_hi:[1,0,1]
    v_cvt_pk_bf16_f32 v198, v204, v205
    v_cvt_pk_bf16_f32 v199, v206, v207
    v_mfma_f32_16x16x16_bf16 v[52:55], v[28:29], v[192:193], 0
    buffer_load_dwordx4 v12, s[28:31], s79 offen offset:1024 lds
    v_mfma_f32_16x16x16_bf16 v[56:59], v[28:29], v[194:195], 0
    v_mfma_f32_16x16x16_bf16 v[60:63], v[28:29], v[196:197], 0
    s_add_u32 s79, s12, 0
    s_and_b32 s79, s79, 0x380
    v_mfma_f32_16x16x16_bf16 v[64:67], v[28:29], v[198:199], 0
    s_mul_i32 s79, s79, 1536
    s_add_u32 m0, s22, 98304
    v_pk_mul_f32 v[200:201], v[176:177], v[104:105]
    v_pk_mul_f32 v[202:203], v[178:179], v[104:105]
    buffer_load_dwordx4 v13, s[28:31], s79 offen lds
    v_pk_fma_f32 v[200:201], v[68:69], v[160:161], v[200:201]
    v_pk_fma_f32 v[202:203], v[70:71], v[162:163], v[202:203]
    v_cvt_pk_bf16_f32 v208, v200, v201
    v_cvt_pk_bf16_f32 v209, v202, v203
    v_pk_mul_f32 v[204:205], v[180:181], v[104:105]
    v_pk_mul_f32 v[206:207], v[182:183], v[104:105]
    v_pk_fma_f32 v[204:205], v[72:73], v[164:165], v[204:205]
    v_pk_fma_f32 v[206:207], v[74:75], v[166:167], v[206:207]
    v_cvt_pk_bf16_f32 v210, v204, v205
    v_cvt_pk_bf16_f32 v211, v206, v207
    v_pk_mul_f32 v[200:201], v[184:185], v[104:105]
    v_pk_mul_f32 v[202:203], v[186:187], v[104:105]
    v_pk_fma_f32 v[200:201], v[76:77], v[168:169], v[200:201]
    buffer_load_dwordx4 v12, s[28:31], s79 offen offset:1024 lds
    v_pk_fma_f32 v[202:203], v[78:79], v[170:171], v[202:203]
    v_cvt_pk_bf16_f32 v212, v200, v201
    v_cvt_pk_bf16_f32 v213, v202, v203
    v_pk_mul_f32 v[204:205], v[188:189], v[104:105]
    v_pk_mul_f32 v[206:207], v[190:191], v[104:105]
    v_pk_fma_f32 v[204:205], v[80:81], v[172:173], v[204:205]
    v_pk_fma_f32 v[206:207], v[82:83], v[174:175], v[206:207]
    v_cvt_pk_bf16_f32 v214, v204, v205
    v_cvt_pk_bf16_f32 v215, v206, v207
    s_xor_b32 s79, s13, 0
    v_max3_f32 v232, v52, v53, v54
    s_xor_b32 m0, s14, 0
    v_min3_f32 v236, v52, v53, v54
    buffer_load_dwordx4 v240, s[36:39], s79 offen offset:0 lds
    v_max3_f32 v233, v56, v57, v58
    v_min3_f32 v237, v56, v57, v58
    v_max3_f32 v234, v60, v61, v62
    v_min3_f32 v238, v60, v61, v62
    v_max3_f32 v235, v64, v65, v66
    v_min3_f32 v239, v64, v65, v66
    v_max_f32 v232, v232, v55
    v_min_f32 v236, v236, v55
    v_max_f32 v233, v233, v59
    v_min_f32 v237, v237, v59
    v_max_f32 v234, v234, v63
    v_min_f32 v238, v238, v63
    v_max_f32 v235, v235, v67
    buffer_load_dwordx4 v241, s[36:39], s79 offen offset:1024 lds
    v_min_f32 v239, v239, v67
    v_permlane32_swap_b32 v232, v233
    v_permlane32_swap_b32 v236, v237
    v_permlane32_swap_b32 v234, v235
    v_permlane32_swap_b32 v238, v239
    v_max_f32 v232, v232, v233
    v_min_f32 v236, v236, v237
    v_max_f32 v234, v234, v235
    v_min_f32 v238, v238, v239
    buffer_load_dwordx4 v242, s[36:39], s79 offen offset:2048 lds
    v_permlane16_swap_b32 v232, v234
    v_permlane16_swap_b32 v236, v238
    v_max_f32 v232, v232, v234
    v_min_f32 v236, v236, v238
    v_mul_f32 v232, s88, v232
    v_mul_f32 v236, s88, v236
    v_mov_b32 v234, v232
    v_mov_b32 v238, v236
    s_nop 0
    v_permlane16_swap_b32 v232, v234
    v_permlane16_swap_b32 v236, v238
    buffer_load_dwordx4 v243, s[36:39], s79 offen offset:3072 lds
    v_mov_b32 v233, v232
    v_mov_b32 v237, v236
    v_mov_b32 v235, v234
    v_mov_b32 v239, v238
    v_permlane32_swap_b32 v232, v233
    v_permlane32_swap_b32 v236, v237
    v_permlane32_swap_b32 v234, v235
    s_xor_b32 s79, s13, 131072
    v_permlane32_swap_b32 v238, v239
    s_xor_b32 m0, s14, 16384
    v_pk_fma_f32 v[216:217], v[52:53], s[88:89], v[232:233] op_sel:[0,0,0] op_sel_hi:[1,1,0] neg_lo:[0,0,1] neg_hi:[0,0,1]
    buffer_load_dwordx4 v240, s[36:39], s79 offen offset:0 lds
    v_pk_fma_f32 v[68:69], v[52:53], s[88:89], v[236:237] op_sel:[0,0,0] op_sel_hi:[1,1,0] neg_lo:[1,0,0] neg_hi:[1,0,0]
    v_pk_fma_f32 v[218:219], v[54:55], s[88:89], v[232:233] op_sel:[0,0,0] op_sel_hi:[1,1,0] neg_lo:[0,0,1] neg_hi:[0,0,1]
    v_pk_fma_f32 v[70:71], v[54:55], s[88:89], v[236:237] op_sel:[0,0,0] op_sel_hi:[1,1,0] neg_lo:[1,0,0] neg_hi:[1,0,0]
    v_exp_f32 v216, v216
    v_exp_f32 v68, v68
    v_exp_f32 v217, v217
    v_exp_f32 v69, v69
    v_exp_f32 v218, v218
    buffer_load_dwordx4 v241, s[36:39], s79 offen offset:1024 lds
    v_exp_f32 v70, v70
    v_exp_f32 v219, v219
    v_exp_f32 v71, v71
    v_pk_fma_f32 v[220:221], v[56:57], s[88:89], v[232:233] op_sel:[0,0,1] op_sel_hi:[1,1,1] neg_lo:[0,0,1] neg_hi:[0,0,1]
    v_pk_fma_f32 v[72:73], v[56:57], s[88:89], v[236:237] op_sel:[0,0,1] op_sel_hi:[1,1,1] neg_lo:[1,0,0] neg_hi:[1,0,0]
    v_pk_fma_f32 v[222:223], v[58:59], s[88:89], v[232:233] op_sel:[0,0,1] op_sel_hi:[1,1,1] neg_lo:[0,0,1] neg_hi:[0,0,1]
    v_pk_fma_f32 v[74:75], v[58:59], s[88:89], v[236:237] op_sel:[0,0,1] op_sel_hi:[1,1,1] neg_lo:[1,0,0] neg_hi:[1,0,0]
    v_exp_f32 v220, v220
    v_exp_f32 v72, v72
    buffer_load_dwordx4 v242, s[36:39], s79 offen offset:2048 lds
    v_exp_f32 v221, v221
    v_exp_f32 v73, v73
    v_exp_f32 v222, v222
    v_exp_f32 v74, v74
    v_exp_f32 v223, v223
    v_exp_f32 v75, v75
    v_pk_fma_f32 v[224:225], v[60:61], s[88:89], v[234:235] op_sel:[0,0,0] op_sel_hi:[1,1,0] neg_lo:[0,0,1] neg_hi:[0,0,1]
    buffer_load_dwordx4 v243, s[36:39], s79 offen offset:3072 lds
    v_pk_fma_f32 v[76:77], v[60:61], s[88:89], v[238:239] op_sel:[0,0,0] op_sel_hi:[1,1,0] neg_lo:[1,0,0] neg_hi:[1,0,0]
    v_pk_fma_f32 v[226:227], v[62:63], s[88:89], v[234:235] op_sel:[0,0,0] op_sel_hi:[1,1,0] neg_lo:[0,0,1] neg_hi:[0,0,1]
    v_pk_fma_f32 v[78:79], v[62:63], s[88:89], v[238:239] op_sel:[0,0,0] op_sel_hi:[1,1,0] neg_lo:[1,0,0] neg_hi:[1,0,0]
    v_exp_f32 v224, v224
    v_exp_f32 v76, v76
    v_exp_f32 v225, v225
    s_xor_b32 s79, s13, 262144
    v_exp_f32 v77, v77
    s_xor_b32 m0, s14, 32768
    v_exp_f32 v226, v226
    buffer_load_dwordx4 v240, s[36:39], s79 offen offset:0 lds
    v_exp_f32 v78, v78
    v_exp_f32 v227, v227
    v_exp_f32 v79, v79
    v_pk_fma_f32 v[228:229], v[64:65], s[88:89], v[234:235] op_sel:[0,0,1] op_sel_hi:[1,1,1] neg_lo:[0,0,1] neg_hi:[0,0,1]
    v_pk_fma_f32 v[80:81], v[64:65], s[88:89], v[238:239] op_sel:[0,0,1] op_sel_hi:[1,1,1] neg_lo:[1,0,0] neg_hi:[1,0,0]
    v_pk_fma_f32 v[230:231], v[66:67], s[88:89], v[234:235] op_sel:[0,0,1] op_sel_hi:[1,1,1] neg_lo:[0,0,1] neg_hi:[0,0,1]
    v_pk_fma_f32 v[82:83], v[66:67], s[88:89], v[238:239] op_sel:[0,0,1] op_sel_hi:[1,1,1] neg_lo:[1,0,0] neg_hi:[1,0,0]
    v_exp_f32 v228, v228
    v_exp_f32 v80, v80
    buffer_load_dwordx4 v241, s[36:39], s79 offen offset:1024 lds
    v_exp_f32 v229, v229
    v_exp_f32 v81, v81
    v_exp_f32 v230, v230
    v_exp_f32 v82, v82
    v_exp_f32 v231, v231
    v_exp_f32 v83, v83
    v_pk_add_f32 v[52:53], v[216:217], v[218:219]
    buffer_load_dwordx4 v242, s[36:39], s79 offen offset:2048 lds
    v_pk_add_f32 v[54:55], v[68:69], v[70:71]
    v_pk_add_f32 v[56:57], v[220:221], v[222:223]
    v_pk_add_f32 v[58:59], v[72:73], v[74:75]
    v_pk_add_f32 v[60:61], v[224:225], v[226:227]
    v_pk_add_f32 v[62:63], v[76:77], v[78:79]
    v_pk_add_f32 v[64:65], v[228:229], v[230:231]
    v_pk_add_f32 v[66:67], v[80:81], v[82:83]
    v_add_f32 v232, v52, v53
    v_add_f32 v236, v54, v55
    v_add_f32 v233, v56, v57
    v_add_f32 v237, v58, v59
    v_add_f32 v234, v60, v61
    v_add_f32 v238, v62, v63
    buffer_load_dwordx4 v243, s[36:39], s79 offen offset:3072 lds
    v_add_f32 v235, v64, v65
    v_add_f32 v239, v66, v67
    v_permlane32_swap_b32 v232, v233
    v_permlane32_swap_b32 v236, v237
    v_permlane32_swap_b32 v234, v235
    v_permlane32_swap_b32 v238, v239
    s_xor_b32 s79, s13, 393216
    v_add_f32 v232, v232, v233
    s_xor_b32 m0, s14, 49152
    v_add_f32 v236, v236, v237
    buffer_load_dwordx4 v240, s[36:39], s79 offen offset:0 lds
    v_add_f32 v234, v234, v235
    v_add_f32 v238, v238, v239
    s_nop 0
    v_permlane16_swap_b32 v232, v234
    v_permlane16_swap_b32 v236, v238
    v_add_f32 v232, v232, v234
    v_add_f32 v236, v236, v238
    v_rcp_f32 v232, v232
    v_rcp_f32 v236, v236
    v_mov_b32 v234, v232
    buffer_load_dwordx4 v241, s[36:39], s79 offen offset:1024 lds
    v_mov_b32 v238, v236
    v_permlane16_swap_b32 v232, v234
    s_nop 0
    v_permlane16_swap_b32 v236, v238
    buffer_load_dwordx4 v242, s[36:39], s79 offen offset:2048 lds
    buffer_load_dwordx4 v243, s[36:39], s79 offen offset:3072 lds
    v_mov_b32 v233, v232
    v_mov_b32 v237, v236
    v_mov_b32 v235, v234
    v_mov_b32 v239, v238
    v_permlane32_swap_b32 v232, v233
    v_permlane32_swap_b32 v236, v237
    v_permlane32_swap_b32 v234, v235
    v_permlane32_swap_b32 v238, v239
    v_pk_mul_f32 v[216:217], v[216:217], v[232:233] op_sel:[0,0] op_sel_hi:[1,0]
    v_pk_mul_f32 v[68:69], v[68:69], v[236:237] op_sel:[0,0] op_sel_hi:[1,0]
    v_pk_mul_f32 v[218:219], v[218:219], v[232:233] op_sel:[0,0] op_sel_hi:[1,0]
    v_pk_mul_f32 v[70:71], v[70:71], v[236:237] op_sel:[0,0] op_sel_hi:[1,0]
    v_cvt_pk_bf16_f32 v240, v216, v217
    v_cvt_pk_bf16_f32 v241, v218, v219
    s_add_u32 s79, s15, 0
    v_cvt_pk_bf16_f32 v242, v68, v69
    s_add_u32 m0, s95, 65536
    v_cvt_pk_bf16_f32 v243, v70, v71
    buffer_load_dwordx4 v9, s[40:43], s79 offen offset:0 lds
    v_pk_mul_f32 v[220:221], v[220:221], v[232:233] op_sel:[0,1] op_sel_hi:[1,1]
    v_pk_mul_f32 v[72:73], v[72:73], v[236:237] op_sel:[0,1] op_sel_hi:[1,1]
    v_pk_mul_f32 v[222:223], v[222:223], v[232:233] op_sel:[0,1] op_sel_hi:[1,1]
    v_pk_mul_f32 v[74:75], v[74:75], v[236:237] op_sel:[0,1] op_sel_hi:[1,1]
    v_cvt_pk_bf16_f32 v244, v220, v221
    v_cvt_pk_bf16_f32 v245, v222, v223
    v_cvt_pk_bf16_f32 v246, v72, v73
    v_cvt_pk_bf16_f32 v247, v74, v75
    v_pk_mul_f32 v[224:225], v[224:225], v[234:235] op_sel:[0,0] op_sel_hi:[1,0]
    v_pk_mul_f32 v[76:77], v[76:77], v[238:239] op_sel:[0,0] op_sel_hi:[1,0]
    v_pk_mul_f32 v[226:227], v[226:227], v[234:235] op_sel:[0,0] op_sel_hi:[1,0]
    v_pk_mul_f32 v[78:79], v[78:79], v[238:239] op_sel:[0,0] op_sel_hi:[1,0]
    v_cvt_pk_bf16_f32 v248, v224, v225
    v_cvt_pk_bf16_f32 v249, v226, v227
    v_cvt_pk_bf16_f32 v250, v76, v77
    v_cvt_pk_bf16_f32 v251, v78, v79
    v_pk_mul_f32 v[228:229], v[228:229], v[234:235] op_sel:[0,1] op_sel_hi:[1,1]
    v_pk_mul_f32 v[80:81], v[80:81], v[238:239] op_sel:[0,1] op_sel_hi:[1,1]
    v_pk_mul_f32 v[230:231], v[230:231], v[234:235] op_sel:[0,1] op_sel_hi:[1,1]
    v_pk_mul_f32 v[82:83], v[82:83], v[238:239] op_sel:[0,1] op_sel_hi:[1,1]
    v_cvt_pk_bf16_f32 v252, v228, v229
    buffer_load_dwordx4 v10, s[40:43], s79 offen offset:1024 lds
    v_cvt_pk_bf16_f32 v253, v230, v231
    v_cvt_pk_bf16_f32 v254, v80, v81
    v_cvt_pk_bf16_f32 v255, v82, v83
    v_mfma_f32_16x16x16_bf16 v[216:219], v[240:241], v[30:31], 0
    v_mfma_f32_16x16x16_bf16 v[68:71], v[242:243], v[30:31], 0
    v_mfma_f32_16x16x16_bf16 v[220:223], v[244:245], v[30:31], 0
    v_mfma_f32_16x16x16_bf16 v[72:75], v[246:247], v[30:31], 0
    v_mfma_f32_16x16x16_bf16 v[224:227], v[248:249], v[30:31], 0
    buffer_load_dwordx4 v11, s[40:43], s79 offen offset:2048 lds
    v_mfma_f32_16x16x16_bf16 v[76:79], v[250:251], v[30:31], 0
    v_mfma_f32_16x16x16_bf16 v[228:231], v[252:253], v[30:31], 0
    v_mfma_f32_16x16x16_bf16 v[80:83], v[254:255], v[30:31], 0
    v_cvt_pk_bf16_f32 v192, v216, v217
    v_cvt_pk_bf16_f32 v193, v218, v219
    v_cvt_pk_bf16_f32 v200, v68, v69
    v_cvt_pk_bf16_f32 v201, v70, v71
    v_cvt_pk_bf16_f32 v194, v220, v221
    v_cvt_pk_bf16_f32 v195, v222, v223
    v_cvt_pk_bf16_f32 v202, v72, v73
    v_cvt_pk_bf16_f32 v203, v74, v75
    v_cvt_pk_bf16_f32 v196, v224, v225
    v_cvt_pk_bf16_f32 v197, v226, v227
    v_cvt_pk_bf16_f32 v204, v76, v77
    v_cvt_pk_bf16_f32 v205, v78, v79
    v_cvt_pk_bf16_f32 v198, v228, v229
    v_cvt_pk_bf16_f32 v199, v230, v231
    v_cvt_pk_bf16_f32 v206, v80, v81
    v_cvt_pk_bf16_f32 v207, v82, v83
    v_mfma_f32_16x16x32_bf16 v[52:55], v[192:195], v[208:211], 0
    v_mfma_f32_16x16x32_bf16 v[56:59], v[200:203], v[208:211], 0
    v_mfma_f32_16x16x32_bf16 v[64:67], v[32:35], v[192:195], 0
    v_mfma_f32_16x16x32_bf16 v[232:235], v[32:35], v[200:203], 0
    v_mfma_f32_16x16x32_bf16 v[52:55], v[196:199], v[212:215], v[52:55]
    v_mfma_f32_16x16x32_bf16 v[56:59], v[204:207], v[212:215], v[56:59]
    v_mfma_f32_16x16x32_bf16 v[64:67], v[32:35], v[196:199], v[64:67]
    v_mfma_f32_16x16x32_bf16 v[232:235], v[32:35], v[204:207], v[232:235]
    s_mov_b32 s76, s17
    s_mov_b32 s73, s18
    v_cmp_gt_u32 vcc, 16, v1
    v_mov_b32 v63, s70
    s_nop 0
    v_mov_b32 v60, v55
    v_mov_b32 v61, v59
    v_mov_b32 v55, s70
    v_mov_b32 v59, s70
    v_cndmask_b32 v62, v232, v64, vcc
    buffer_store_dwordx4 v[52:55], v8, s[32:35], s73 offen offset:0 sc1
    buffer_store_dwordx4 v[56:59], v8, s[32:35], s73 offen offset:1024 sc1
    buffer_store_dwordx4 v[60:63], v8, s[32:35], s73 offen offset:2048 sc1
    s_waitcnt vmcnt(22)
    s_barrier
    ds_read_b64_tr_b16 v[120:121], v16 offset:0
    ds_read_b64_tr_b16 v[122:123], v16 offset:512
    ds_read_b64_tr_b16 v[124:125], v16 offset:4096
    ds_read_b64_tr_b16 v[126:127], v16 offset:4608
    ds_read_b64_tr_b16 v[128:129], v16 offset:8192
    ds_read_b64_tr_b16 v[130:131], v16 offset:8704
    ds_read_b64_tr_b16 v[132:133], v16 offset:12288
    ds_read_b64_tr_b16 v[134:135], v16 offset:12800
    ds_read_b64_tr_b16 v[136:137], v16 offset:16384
    ds_read_b64_tr_b16 v[138:139], v16 offset:16896
    ds_read_b64_tr_b16 v[140:141], v16 offset:20480
    ds_read_b64_tr_b16 v[142:143], v16 offset:20992
    s_waitcnt lgkmcnt(8)
    v_mfma_f32_16x16x32_bf16 v[84:87], v[120:123], a[0:3], 0
    ds_read_b64_tr_b16 v[144:145], v16 offset:24576
    v_lshrrev_b32 v4, 2, v2
    v_mfma_f32_16x16x32_bf16 v[88:91], v[120:123], a[4:7], 0
    v_lshl_add_u32 v4, v3, 2, v4
    v_bfe_u32 v20, v4, 1, 2
    v_mfma_f32_16x16x32_bf16 v[92:95], v[120:123], a[8:11], 0
    ds_read_b64_tr_b16 v[146:147], v16 offset:25088
    v_lshlrev_b32 v4, 7, v4
    v_mfma_f32_16x16x32_bf16 v[96:99], v[120:123], a[12:15], 0
    v_lshl_add_u32 v4, v20, 5, v4
    v_and_b32 v20, 3, v2
    v_mfma_f32_16x16x32_bf16 v[108:111], v[120:123], v[32:35], 0
    v_lshl_add_u32 v20, v20, 3, v4
    v_xor_b32 v21, 32, v20
    v_mfma_f32_16x16x32_bf16 v[84:87], v[124:127], a[16:19], v[84:87]
    ds_read_b64_tr_b16 v[148:149], v16 offset:28672
    v_xor_b32 v22, 64, v20
    v_mfma_f32_16x16x32_bf16 v[88:91], v[124:127], a[20:23], v[88:91]
    v_mfma_f32_16x16x32_bf16 v[92:95], v[124:127], a[24:27], v[92:95]
    ds_read_b64_tr_b16 v[150:151], v16 offset:29184
    v_mfma_f32_16x16x32_bf16 v[96:99], v[124:127], a[28:31], v[96:99]
    v_mfma_f32_16x16x32_bf16 v[108:111], v[124:127], v[32:35], v[108:111]
    s_waitcnt lgkmcnt(8)
    v_mfma_f32_16x16x32_bf16 v[84:87], v[128:131], a[32:35], v[84:87]
    ds_read_b64_tr_b16 v[120:121], v16 offset:32768
    v_xor_b32 v23, 96, v20
    v_mfma_f32_16x16x32_bf16 v[88:91], v[128:131], a[36:39], v[88:91]
    v_lshrrev_b32 v24, 2, v2
    v_lshl_add_u32 v24, v6, 3, v24
    v_mfma_f32_16x16x32_bf16 v[92:95], v[128:131], a[40:43], v[92:95]
    ds_read_b64_tr_b16 v[122:123], v16 offset:33280
    v_mul_u32_u24 v24, 192, v24
    v_mfma_f32_16x16x32_bf16 v[96:99], v[128:131], a[44:47], v[96:99]
    v_lshl_add_u32 v24, v7, 5, v24
    v_and_b32 v18, 3, v2
    v_mfma_f32_16x16x32_bf16 v[108:111], v[128:131], v[32:35], v[108:111]
    v_lshl_add_u32 v24, v18, 3, v24
    v_add_u32 v18, 0x10000, v24
    v_mfma_f32_16x16x32_bf16 v[84:87], v[132:135], a[48:51], v[84:87]
    ds_read_b64_tr_b16 v[124:125], v16 offset:36864
    v_add_u32 v19, 114688, v24
    v_mfma_f32_16x16x32_bf16 v[88:91], v[132:135], a[52:55], v[88:91]
    v_mfma_f32_16x16x32_bf16 v[92:95], v[132:135], a[56:59], v[92:95]
    ds_read_b64_tr_b16 v[126:127], v16 offset:37376
    v_mfma_f32_16x16x32_bf16 v[96:99], v[132:135], a[60:63], v[96:99]
    v_mfma_f32_16x16x32_bf16 v[108:111], v[132:135], v[32:35], v[108:111]
    s_waitcnt lgkmcnt(8)
    v_mfma_f32_16x16x32_bf16 v[84:87], v[136:139], a[64:67], v[84:87]
    ds_read_b64_tr_b16 v[128:129], v16 offset:40960
    s_lshl_b32 s73, s67, 7
    v_mfma_f32_16x16x32_bf16 v[88:91], v[136:139], a[68:71], v[88:91]
    s_sub_u32 s74, 1409024, s73
    v_mfma_f32_16x16x32_bf16 v[92:95], v[136:139], a[72:75], v[92:95]
    ds_read_b64_tr_b16 v[130:131], v16 offset:41472
    v_mfma_f32_16x16x32_bf16 v[96:99], v[136:139], a[76:79], v[96:99]
    s_add_u32 s44, s44, s73
    s_addc_u32 s45, s45, 0
    v_mfma_f32_16x16x32_bf16 v[108:111], v[136:139], v[32:35], v[108:111]
    s_and_b32 s45, s45, 0xffff
    s_mov_b32 s46, s74
    v_mfma_f32_16x16x32_bf16 v[84:87], v[140:143], a[80:83], v[84:87]
    ds_read_b64_tr_b16 v[132:133], v16 offset:45056
    s_mov_b32 s47, 0x20000
    v_mfma_f32_16x16x32_bf16 v[88:91], v[140:143], a[84:87], v[88:91]
    s_and_b32 s57, s57, 0xffff
    s_mov_b32 s58, 2097152
    v_mfma_f32_16x16x32_bf16 v[92:95], v[140:143], a[88:91], v[92:95]
    ds_read_b64_tr_b16 v[134:135], v16 offset:45568
    s_mov_b32 s59, 0x20000
    v_mfma_f32_16x16x32_bf16 v[96:99], v[140:143], a[92:95], v[96:99]
    v_mfma_f32_16x16x32_bf16 v[108:111], v[140:143], v[32:35], v[108:111]
    s_waitcnt lgkmcnt(8)
    v_mfma_f32_16x16x32_bf16 v[84:87], v[144:147], a[96:99], v[84:87]
    ds_read_b64_tr_b16 v[136:137], v16 offset:49152
    s_lshl_b32 s20, s3, 14
    v_mfma_f32_16x16x32_bf16 v[88:91], v[144:147], a[100:103], v[88:91]
    s_mul_i32 s21, s3, 6144
    s_add_u32 s21, s21, 65536
    v_mfma_f32_16x16x32_bf16 v[92:95], v[144:147], a[104:107], v[92:95]
    ds_read_b64_tr_b16 v[138:139], v16 offset:49664
    s_add_u32 s24, s19, 0
    v_mfma_f32_16x16x32_bf16 v[96:99], v[144:147], a[108:111], v[96:99]
    s_add_u32 s17, s19, 4293525504
    s_min_u32 s24, s24, s17
    v_mfma_f32_16x16x32_bf16 v[108:111], v[144:147], v[32:35], v[108:111]
    s_add_u32 s25, s19, 32768
    v_mfma_f32_16x16x32_bf16 v[84:87], v[148:151], a[112:115], v[84:87]
    ds_read_b64_tr_b16 v[140:141], v16 offset:53248
    v_mfma_f32_16x16x32_bf16 v[88:91], v[148:151], a[116:119], v[88:91]
    v_mfma_f32_16x16x32_bf16 v[92:95], v[148:151], a[120:123], v[92:95]
    ds_read_b64_tr_b16 v[142:143], v16 offset:53760
    v_mfma_f32_16x16x32_bf16 v[96:99], v[148:151], a[124:127], v[96:99]
    v_mfma_f32_16x16x32_bf16 v[108:111], v[148:151], v[32:35], v[108:111]
    s_waitcnt vmcnt(6)
    s_barrier
    s_cmp_eq_u32 s68, s3
    s_cbranch_scc0 L_l1back
    s_xor_b32 s75, s68, 1
    s_mul_i32 s75, s75, 3072
    s_add_u32 s75, s75, s76
    buffer_load_dwordx4 v[216:219], v8, s[32:35], s75 offen offset:0 sc1
    buffer_load_dwordx4 v[220:223], v8, s[32:35], s75 offen offset:1024 sc1
    buffer_load_dwordx4 v[224:227], v8, s[32:35], s75 offen offset:2048 sc1
    s_xor_b32 s75, s68, 2
    s_mul_i32 s75, s75, 3072
    s_add_u32 s75, s75, s76
    buffer_load_dwordx4 v[228:231], v8, s[32:35], s75 offen offset:0 sc1
    buffer_load_dwordx4 v[232:235], v8, s[32:35], s75 offen offset:1024 sc1
    buffer_load_dwordx4 v[236:239], v8, s[32:35], s75 offen offset:2048 sc1
    s_xor_b32 s75, s68, 3
    s_mul_i32 s75, s75, 3072
    s_add_u32 s75, s75, s76
    buffer_load_dwordx4 v[240:243], v8, s[32:35], s75 offen offset:0 sc1
    buffer_load_dwordx4 v[244:247], v8, s[32:35], s75 offen offset:1024 sc1
    buffer_load_dwordx4 v[248:251], v8, s[32:35], s75 offen offset:2048 sc1
L_l1back:
    s_waitcnt lgkmcnt(8)
    v_mfma_f32_16x16x32_bf16 v[84:87], v[120:123], a[128:131], v[84:87]
    ds_read_b64_tr_b16 v[144:145], v16 offset:57344
    ds_read_b64_tr_b16 v[146:147], v16 offset:57856
    v_mfma_f32_16x16x32_bf16 v[88:91], v[120:123], a[132:135], v[88:91]
    ds_read_b64_tr_b16 v[148:149], v16 offset:61440
    ds_read_b64_tr_b16 v[150:151], v16 offset:61952
    v_mfma_f32_16x16x32_bf16 v[92:95], v[120:123], a[136:139], v[92:95]
    ds_read_b64_tr_b16 a[0:1], v20 offset:0
    ds_read_b64_tr_b16 a[2:3], v20 offset:2048
    v_mfma_f32_16x16x32_bf16 v[96:99], v[120:123], a[140:143], v[96:99]
    ds_read_b64_tr_b16 a[4:5], v21 offset:0
    ds_read_b64_tr_b16 a[6:7], v21 offset:2048
    v_mfma_f32_16x16x32_bf16 v[108:111], v[120:123], v[32:35], v[108:111]
    ds_read_b64_tr_b16 a[8:9], v22 offset:0
    ds_read_b64_tr_b16 a[10:11], v22 offset:2048
    v_mfma_f32_16x16x32_bf16 v[84:87], v[124:127], a[144:147], v[84:87]
    ds_read_b64_tr_b16 a[12:13], v23 offset:0
    ds_read_b64_tr_b16 a[14:15], v23 offset:2048
    v_mfma_f32_16x16x32_bf16 v[88:91], v[124:127], a[148:151], v[88:91]
    ds_read_b64_tr_b16 a[16:17], v20 offset:4096
    ds_read_b64_tr_b16 a[18:19], v20 offset:6144
    v_mfma_f32_16x16x32_bf16 v[92:95], v[124:127], a[152:155], v[92:95]
    ds_read_b64_tr_b16 a[20:21], v21 offset:4096
    ds_read_b64_tr_b16 a[22:23], v21 offset:6144
    v_mfma_f32_16x16x32_bf16 v[96:99], v[124:127], a[156:159], v[96:99]
    ds_read_b64_tr_b16 a[24:25], v22 offset:4096
    ds_read_b64_tr_b16 a[26:27], v22 offset:6144
    v_mfma_f32_16x16x32_bf16 v[108:111], v[124:127], v[32:35], v[108:111]
    ds_read_b64_tr_b16 a[28:29], v23 offset:4096
    ds_read_b64_tr_b16 a[30:31], v23 offset:6144
    s_cmp_eq_u32 s68, s3
    s_cbranch_scc0 L_nolead
    s_waitcnt vmcnt(0)
    s_mov_b32 s78, 0
L_sw_4:
    v_xor_b32 v209, s70, v219
    v_xor_b32 v210, s70, v223
    v_xor_b32 v211, s70, v227
    v_or3_b32 v208, v209, v210, v211
    v_xor_b32 v209, s70, v231
    v_xor_b32 v210, s70, v235
    v_xor_b32 v211, s70, v239
    v_or_b32 v209, v208, v209
    v_or3_b32 v208, v209, v210, v211
    v_xor_b32 v209, s70, v243
    v_xor_b32 v210, s70, v247
    v_xor_b32 v211, s70, v251
    v_or_b32 v209, v208, v209
    v_or3_b32 v208, v209, v210, v211
    v_cmp_ne_u32 vcc, 0, v208
    s_cbranch_vccnz L_swr_6
L_swx_5:
    v_pk_add_f32 v[52:53], v[52:53], v[216:217]
    v_add_f32 v54, v54, v218
    v_pk_add_f32 v[56:57], v[56:57], v[220:221]
    v_add_f32 v58, v58, v222
    v_pk_add_f32 v[60:61], v[60:61], v[224:225]
    v_add_f32 v62, v62, v226
    v_pk_add_f32 v[52:53], v[52:53], v[228:229]
    v_add_f32 v54, v54, v230
    v_pk_add_f32 v[56:57], v[56:57], v[232:233]
    v_add_f32 v58, v58, v234
    v_pk_add_f32 v[60:61], v[60:61], v[236:237]
    v_add_f32 v62, v62, v238
    v_pk_add_f32 v[52:53], v[52:53], v[240:241]
    v_add_f32 v54, v54, v242
    v_pk_add_f32 v[56:57], v[56:57], v[244:245]
    v_add_f32 v58, v58, v246
    v_pk_add_f32 v[60:61], v[60:61], v[248:249]
    v_add_f32 v62, v62, v250
    s_lshl_b32 s73, s69, 3
    s_add_u32 s73, s73, s64
    s_lshl_b32 s73, s73, 11
    s_add_u32 s73, s73, 4194304
    v_cvt_pk_bf16_f32 v218, v52, v53
    v_cvt_pk_bf16_f32 v219, v54, v60
    v_mov_b32 v216, v62
    v_mov_b32 v217, s70
    v_cvt_pk_bf16_f32 v220, v56, v57
    v_cvt_pk_bf16_f32 v221, v58, v61
    v_mov_b32 v223, s70
    buffer_store_dwordx4 v[216:219], v8, s[32:35], s73 offen offset:0 sc1
    buffer_store_dwordx4 v[220:223], v8, s[32:35], s73 offen offset:1024 sc1
L_nolead:
    s_waitcnt lgkmcnt(15)
    v_mfma_f32_16x16x32_bf16 v[84:87], v[128:131], a[160:163], v[84:87]
    ds_read_b64_tr_b16 a[32:33], v20 offset:8192
    ds_read_b64_tr_b16 a[34:35], v20 offset:10240
    v_mfma_f32_16x16x32_bf16 v[88:91], v[128:131], a[164:167], v[88:91]
    ds_read_b64_tr_b16 a[36:37], v21 offset:8192
    ds_read_b64_tr_b16 a[38:39], v21 offset:10240
    v_mfma_f32_16x16x32_bf16 v[92:95], v[128:131], a[168:171], v[92:95]
    ds_read_b64_tr_b16 a[40:41], v22 offset:8192
    s_add_u32 s79, s15, 176128
    v_mfma_f32_16x16x32_bf16 v[96:99], v[128:131], a[172:175], v[96:99]
    ds_read_b64_tr_b16 a[42:43], v22 offset:10240
    ds_read_b64_tr_b16 a[44:45], v23 offset:8192
    v_mfma_f32_16x16x32_bf16 v[108:111], v[128:131], v[32:35], v[108:111]
    ds_read_b64_tr_b16 a[46:47], v23 offset:10240
    s_add_u32 m0, s95, 77824
    s_nop 0
    buffer_load_dwordx4 v9, s[40:43], s79 offen offset:0 lds
    v_mfma_f32_16x16x32_bf16 v[84:87], v[132:135], a[176:179], v[84:87]
    ds_read_b64_tr_b16 a[48:49], v20 offset:12288
    ds_read_b64_tr_b16 a[50:51], v20 offset:14336
    v_mfma_f32_16x16x32_bf16 v[88:91], v[132:135], a[180:183], v[88:91]
    ds_read_b64_tr_b16 a[52:53], v21 offset:12288
    ds_read_b64_tr_b16 a[54:55], v21 offset:14336
    v_mfma_f32_16x16x32_bf16 v[92:95], v[132:135], a[184:187], v[92:95]
    ds_read_b64_tr_b16 a[56:57], v22 offset:12288
    v_mfma_f32_16x16x32_bf16 v[96:99], v[132:135], a[188:191], v[96:99]
    ds_read_b64_tr_b16 a[58:59], v22 offset:14336
    ds_read_b64_tr_b16 a[60:61], v23 offset:12288
    v_mfma_f32_16x16x32_bf16 v[108:111], v[132:135], v[32:35], v[108:111]
    ds_read_b64_tr_b16 a[62:63], v23 offset:14336
    s_lshl_b32 s77, s66, 1
    s_add_u32 s77, s77, s92
    s_mul_i32 s77, s77, 86
    s_lshr_b32 s99, s69, 1
    s_add_u32 s77, s77, s99
    s_lshl_b32 s77, s77, 10
    s_add_u32 s77, s77, 10485760
    v_min_u32 v114, 15, v1
    v_lshrrev_b32 v115, 3, v114
    v_mul_u32_u24 v115, 120, v115
    v_add_u32 v114, v114, v115
    v_lshlrev_b32 v114, 7, v114
    buffer_load_dword v115, v114, s[32:35], s77 offen sc1
    s_waitcnt lgkmcnt(15)
    v_mfma_f32_16x16x32_bf16 v[84:87], v[136:139], a[192:195], v[84:87]
    ds_read_b64_tr_b16 a[64:65], v20 offset:16384
    ds_read_b64_tr_b16 a[66:67], v20 offset:18432
    buffer_load_dwordx4 v10, s[40:43], s79 offen offset:1024 lds
    v_mfma_f32_16x16x32_bf16 v[88:91], v[136:139], a[196:199], v[88:91]
    ds_read_b64_tr_b16 a[68:69], v21 offset:16384
    ds_read_b64_tr_b16 a[70:71], v21 offset:18432
    v_mfma_f32_16x16x32_bf16 v[92:95], v[136:139], a[200:203], v[92:95]
    ds_read_b64_tr_b16 a[72:73], v22 offset:16384
    v_mfma_f32_16x16x32_bf16 v[96:99], v[136:139], a[204:207], v[96:99]
    ds_read_b64_tr_b16 a[74:75], v22 offset:18432
    ds_read_b64_tr_b16 a[76:77], v23 offset:16384
    v_mfma_f32_16x16x32_bf16 v[108:111], v[136:139], v[32:35], v[108:111]
    ds_read_b64_tr_b16 a[78:79], v23 offset:18432
    v_mfma_f32_16x16x32_bf16 v[84:87], v[140:143], a[208:211], v[84:87]
    ds_read_b64_tr_b16 a[80:81], v20 offset:20480
    ds_read_b64_tr_b16 a[82:83], v20 offset:22528
    v_mfma_f32_16x16x32_bf16 v[88:91], v[140:143], a[212:215], v[88:91]
    ds_read_b64_tr_b16 a[84:85], v21 offset:20480
    ds_read_b64_tr_b16 a[86:87], v21 offset:22528
    buffer_load_dwordx4 v11, s[40:43], s79 offen offset:2048 lds
    v_mfma_f32_16x16x32_bf16 v[92:95], v[140:143], a[216:219], v[92:95]
    ds_read_b64_tr_b16 a[88:89], v22 offset:20480
    v_mfma_f32_16x16x32_bf16 v[96:99], v[140:143], a[220:223], v[96:99]
    ds_read_b64_tr_b16 a[90:91], v22 offset:22528
    ds_read_b64_tr_b16 a[92:93], v23 offset:20480
    v_mfma_f32_16x16x32_bf16 v[108:111], v[140:143], v[32:35], v[108:111]
    ds_read_b64_tr_b16 a[94:95], v23 offset:22528
    s_waitcnt lgkmcnt(15)
    v_mfma_f32_16x16x32_bf16 v[84:87], v[144:147], a[224:227], v[84:87]
    ds_read_b64_tr_b16 a[96:97], v20 offset:24576
    ds_read_b64_tr_b16 a[98:99], v20 offset:26624
    v_mfma_f32_16x16x32_bf16 v[88:91], v[144:147], a[228:231], v[88:91]
    ds_read_b64_tr_b16 a[100:101], v21 offset:24576
    ds_read_b64_tr_b16 a[102:103], v21 offset:26624
    v_mfma_f32_16x16x32_bf16 v[92:95], v[144:147], a[232:235], v[92:95]
    ds_read_b64_tr_b16 a[104:105], v22 offset:24576
    s_add_u32 s79, s15, 352256
    v_mfma_f32_16x16x32_bf16 v[96:99], v[144:147], a[236:239], v[96:99]
    ds_read_b64_tr_b16 a[106:107], v22 offset:26624
    ds_read_b64_tr_b16 a[108:109], v23 offset:24576
    v_mfma_f32_16x16x32_bf16 v[108:111], v[144:147], v[32:35], v[108:111]
    ds_read_b64_tr_b16 a[110:111], v23 offset:26624
    s_add_u32 m0, s95, 90112
    s_nop 0
    buffer_load_dwordx4 v9, s[40:43], s79 offen offset:0 lds
    v_mfma_f32_16x16x32_bf16 v[84:87], v[148:151], a[240:243], v[84:87]
    ds_read_b64_tr_b16 a[112:113], v20 offset:28672
    ds_read_b64_tr_b16 a[114:115], v20 offset:30720
    v_mfma_f32_16x16x32_bf16 v[88:91], v[148:151], a[244:247], v[88:91]
    ds_read_b64_tr_b16 a[116:117], v21 offset:28672
    ds_read_b64_tr_b16 a[118:119], v21 offset:30720
    v_mfma_f32_16x16x32_bf16 v[92:95], v[148:151], a[248:251], v[92:95]
    ds_read_b64_tr_b16 a[120:121], v22 offset:28672
    v_mfma_f32_16x16x32_bf16 v[96:99], v[148:151], a[252:255], v[96:99]
    ds_read_b64_tr_b16 a[122:123], v22 offset:30720
    ds_read_b64_tr_b16 a[124:125], v23 offset:28672
    v_mfma_f32_16x16x32_bf16 v[108:111], v[148:151], v[32:35], v[108:111]
    ds_read_b64_tr_b16 a[126:127], v23 offset:30720
    s_barrier
    s_waitcnt lgkmcnt(0)
    s_lshl_b32 s78, s66, 1
    s_add_u32 s78, s78, s93
    s_lshl_b32 s78, s78, 3
    s_add_u32 s78, s78, s67
    s_lshl_b32 s78, s78, 1
    s_add_u32 s78, s78, s92
    s_lshl_b32 s78, s78, 7
    s_add_u32 s78, s78, 9437184
    s_add_u32 s98, s32, s78
    s_addc_u32 s99, s33, 0
    s_load_dwordx2 s[0:1], s[98:99], 60
    s_lshl_b32 s78, s66, 7
    s_add_u32 s98, s32, s78
    s_addc_u32 s99, s33, 0
    s_load_dwordx2 s[0:1], s[98:99], 12348
    s_lshl_b32 s78, s78, 1
    s_add_u32 s98, s32, s78
    s_addc_u32 s99, s33, 0
    s_load_dwordx2 s[0:1], s[98:99], 16444
    s_load_dwordx2 s[0:1], s[98:99], 16572
    s_load_dwordx2 s[0:1], s[98:99], 32828
    s_load_dwordx2 s[0:1], s[98:99], 32956
    v_pk_mul_f32 v[200:201], v[108:109], v[152:153] op_sel:[0,1] op_sel_hi:[1,1]
    buffer_load_dwordx4 v10, s[40:43], s79 offen offset:1024 lds
    v_pk_mul_f32 v[202:203], v[110:111], v[152:153] op_sel:[0,1] op_sel_hi:[1,1]
    v_pk_fma_f32 v[200:201], v[84:85], v[152:153], v[200:201] op_sel_hi:[1,0,1]
    v_pk_fma_f32 v[202:203], v[86:87], v[152:153], v[202:203] op_sel_hi:[1,0,1]
    v_cvt_pk_bf16_f32 v192, v200, v201
    v_cvt_pk_bf16_f32 v193, v202, v203
    v_pk_mul_f32 v[204:205], v[108:109], v[154:155] op_sel:[0,1] op_sel_hi:[1,1]
    v_pk_mul_f32 v[206:207], v[110:111], v[154:155] op_sel:[0,1] op_sel_hi:[1,1]
    v_pk_fma_f32 v[204:205], v[88:89], v[154:155], v[204:205] op_sel_hi:[1,0,1]
    v_pk_fma_f32 v[206:207], v[90:91], v[154:155], v[206:207] op_sel_hi:[1,0,1]
    v_cvt_pk_bf16_f32 v194, v204, v205
    v_cvt_pk_bf16_f32 v195, v206, v207
    v_pk_mul_f32 v[200:201], v[108:109], v[156:157] op_sel:[0,1] op_sel_hi:[1,1]
    v_pk_mul_f32 v[202:203], v[110:111], v[156:157] op_sel:[0,1] op_sel_hi:[1,1]
    v_pk_fma_f32 v[200:201], v[92:93], v[156:157], v[200:201] op_sel_hi:[1,0,1]
    v_pk_fma_f32 v[202:203], v[94:95], v[156:157], v[202:203] op_sel_hi:[1,0,1]
    v_cvt_pk_bf16_f32 v196, v200, v201
    v_cvt_pk_bf16_f32 v197, v202, v203
    v_pk_mul_f32 v[204:205], v[108:109], v[158:159] op_sel:[0,1] op_sel_hi:[1,1]
    v_pk_mul_f32 v[206:207], v[110:111], v[158:159] op_sel:[0,1] op_sel_hi:[1,1]
    v_pk_fma_f32 v[204:205], v[96:97], v[158:159], v[204:205] op_sel_hi:[1,0,1]
    v_pk_fma_f32 v[206:207], v[98:99], v[158:159], v[206:207] op_sel_hi:[1,0,1]
    buffer_load_dwordx4 v11, s[40:43], s79 offen offset:2048 lds
    v_cvt_pk_bf16_f32 v198, v204, v205
    v_cvt_pk_bf16_f32 v199, v206, v207
    v_mfma_f32_16x16x16_bf16 v[52:55], v[28:29], v[192:193], 0
    v_mfma_f32_16x16x16_bf16 v[56:59], v[28:29], v[194:195], 0
    v_mfma_f32_16x16x16_bf16 v[60:63], v[28:29], v[196:197], 0
    s_add_u32 s79, s15, 528384
    s_add_u32 m0, s95, 102400
    v_mfma_f32_16x16x16_bf16 v[64:67], v[28:29], v[198:199], 0
    s_nop 2
    v_max3_f32 v232, v52, v53, v54
    v_min3_f32 v236, v52, v53, v54
    v_max3_f32 v233, v56, v57, v58
    buffer_load_dwordx4 v9, s[40:43], s79 offen offset:0 lds
    v_min3_f32 v237, v56, v57, v58
    v_max3_f32 v234, v60, v61, v62
    v_min3_f32 v238, v60, v61, v62
    v_max3_f32 v235, v64, v65, v66
    v_min3_f32 v239, v64, v65, v66
    v_max_f32 v232, v232, v55
    v_min_f32 v236, v236, v55
    v_max_f32 v233, v233, v59
    v_min_f32 v237, v237, v59
    v_max_f32 v234, v234, v63
    v_min_f32 v238, v238, v63
    v_max_f32 v235, v235, v67
    v_min_f32 v239, v239, v67
    v_permlane32_swap_b32 v232, v233
    v_permlane32_swap_b32 v236, v237
    v_permlane32_swap_b32 v234, v235
    v_permlane32_swap_b32 v238, v239
    buffer_load_dwordx4 v10, s[40:43], s79 offen offset:1024 lds
    v_max_f32 v232, v232, v233
    v_min_f32 v236, v236, v237
    v_max_f32 v234, v234, v235
    v_min_f32 v238, v238, v239
    s_nop 0
    v_permlane16_swap_b32 v232, v234
    v_permlane16_swap_b32 v236, v238
    v_max_f32 v232, v232, v234
    v_min_f32 v236, v236, v238
    v_mul_f32 v232, s88, v232
    v_mul_f32 v236, s88, v236
    v_mov_b32 v234, v232
    v_mov_b32 v238, v236
    s_nop 0
    v_permlane16_swap_b32 v232, v234
    v_permlane16_swap_b32 v236, v238
    v_mov_b32 v233, v232
    v_mov_b32 v237, v236
    v_mov_b32 v235, v234
    buffer_load_dwordx4 v11, s[40:43], s79 offen offset:2048 lds
    v_mov_b32 v239, v238
    v_permlane32_swap_b32 v232, v233
    v_permlane32_swap_b32 v236, v237
    v_permlane32_swap_b32 v234, v235
    v_permlane32_swap_b32 v238, v239
    v_pk_fma_f32 v[216:217], v[52:53], s[88:89], v[232:233] op_sel:[0,0,0] op_sel_hi:[1,1,0] neg_lo:[0,0,1] neg_hi:[0,0,1]
    v_pk_fma_f32 v[68:69], v[52:53], s[88:89], v[236:237] op_sel:[0,0,0] op_sel_hi:[1,1,0] neg_lo:[1,0,0] neg_hi:[1,0,0]
    v_pk_fma_f32 v[218:219], v[54:55], s[88:89], v[232:233] op_sel:[0,0,0] op_sel_hi:[1,1,0] neg_lo:[0,0,1] neg_hi:[0,0,1]
    v_pk_fma_f32 v[70:71], v[54:55], s[88:89], v[236:237] op_sel:[0,0,0] op_sel_hi:[1,1,0] neg_lo:[1,0,0] neg_hi:[1,0,0]
    v_exp_f32 v216, v216
    v_exp_f32 v68, v68
    s_sub_u32 s79, 704512, s15
    v_exp_f32 v217, v217
    s_add_u32 m0, s95, 114688
    v_exp_f32 v69, v69
    buffer_load_dwordx4 v9, s[40:43], s79 offen offset:0 lds
    v_exp_f32 v218, v218
    v_exp_f32 v70, v70
    v_exp_f32 v219, v219
    v_exp_f32 v71, v71
    v_pk_fma_f32 v[220:221], v[56:57], s[88:89], v[232:233] op_sel:[0,0,1] op_sel_hi:[1,1,1] neg_lo:[0,0,1] neg_hi:[0,0,1]
    v_pk_fma_f32 v[72:73], v[56:57], s[88:89], v[236:237] op_sel:[0,0,1] op_sel_hi:[1,1,1] neg_lo:[1,0,0] neg_hi:[1,0,0]
    v_pk_fma_f32 v[222:223], v[58:59], s[88:89], v[232:233] op_sel:[0,0,1] op_sel_hi:[1,1,1] neg_lo:[0,0,1] neg_hi:[0,0,1]
    v_pk_fma_f32 v[74:75], v[58:59], s[88:89], v[236:237] op_sel:[0,0,1] op_sel_hi:[1,1,1] neg_lo:[1,0,0] neg_hi:[1,0,0]
    v_exp_f32 v220, v220
    v_exp_f32 v72, v72
    v_exp_f32 v221, v221
    v_exp_f32 v73, v73
    v_exp_f32 v222, v222
    v_exp_f32 v74, v74
    v_exp_f32 v223, v223
    v_exp_f32 v75, v75
    v_pk_fma_f32 v[224:225], v[60:61], s[88:89], v[234:235] op_sel:[0,0,0] op_sel_hi:[1,1,0] neg_lo:[0,0,1] neg_hi:[0,0,1]
    v_pk_fma_f32 v[76:77], v[60:61], s[88:89], v[238:239] op_sel:[0,0,0] op_sel_hi:[1,1,0] neg_lo:[1,0,0] neg_hi:[1,0,0]
    v_pk_fma_f32 v[226:227], v[62:63], s[88:89], v[234:235] op_sel:[0,0,0] op_sel_hi:[1,1,0] neg_lo:[0,0,1] neg_hi:[0,0,1]
    v_pk_fma_f32 v[78:79], v[62:63], s[88:89], v[238:239] op_sel:[0,0,0] op_sel_hi:[1,1,0] neg_lo:[1,0,0] neg_hi:[1,0,0]
    v_exp_f32 v224, v224
    v_exp_f32 v76, v76
    v_exp_f32 v225, v225
    v_exp_f32 v77, v77
    v_exp_f32 v226, v226
    v_exp_f32 v78, v78
    v_exp_f32 v227, v227
    v_exp_f32 v79, v79
    v_pk_fma_f32 v[228:229], v[64:65], s[88:89], v[234:235] op_sel:[0,0,1] op_sel_hi:[1,1,1] neg_lo:[0,0,1] neg_hi:[0,0,1]
    v_pk_fma_f32 v[80:81], v[64:65], s[88:89], v[238:239] op_sel:[0,0,1] op_sel_hi:[1,1,1] neg_lo:[1,0,0] neg_hi:[1,0,0]
    v_pk_fma_f32 v[230:231], v[66:67], s[88:89], v[234:235] op_sel:[0,0,1] op_sel_hi:[1,1,1] neg_lo:[0,0,1] neg_hi:[0,0,1]
    v_pk_fma_f32 v[82:83], v[66:67], s[88:89], v[238:239] op_sel:[0,0,1] op_sel_hi:[1,1,1] neg_lo:[1,0,0] neg_hi:[1,0,0]
    v_exp_f32 v228, v228
    v_exp_f32 v80, v80
    v_exp_f32 v229, v229
    v_exp_f32 v81, v81
    v_exp_f32 v230, v230
    v_exp_f32 v82, v82
    v_exp_f32 v231, v231
    v_exp_f32 v83, v83
    v_pk_add_f32 v[52:53], v[216:217], v[218:219]
    v_pk_add_f32 v[54:55], v[68:69], v[70:71]
    v_pk_add_f32 v[56:57], v[220:221], v[222:223]
    v_pk_add_f32 v[58:59], v[72:73], v[74:75]
    v_pk_add_f32 v[60:61], v[224:225], v[226:227]
    v_pk_add_f32 v[62:63], v[76:77], v[78:79]
    v_pk_add_f32 v[64:65], v[228:229], v[230:231]
    v_pk_add_f32 v[66:67], v[80:81], v[82:83]
    v_add_f32 v232, v52, v53
    v_add_f32 v236, v54, v55
    v_add_f32 v233, v56, v57
    v_add_f32 v237, v58, v59
    v_add_f32 v234, v60, v61
    s_lshl_b32 s76, s69, 14
    v_add_f32 v238, v62, v63
    s_add_u32 s76, s76, 4194304
    v_add_f32 v235, v64, v65
    s_add_u32 s73, s76, 0
    v_add_f32 v239, v66, v67
    buffer_load_dwordx4 v[100:103], v8, s[32:35], s73 offen offset:0 sc1
    v_permlane32_swap_b32 v232, v233
    v_permlane32_swap_b32 v236, v237
    v_permlane32_swap_b32 v234, v235
    buffer_load_dwordx4 v[108:111], v8, s[32:35], s73 offen offset:2048 sc1
    v_permlane32_swap_b32 v238, v239
    s_add_u32 s74, s76, 4096
    v_add_f32 v232, v232, v233
    v_add_f32 v236, v236, v237
    buffer_load_dwordx4 v[116:119], v8, s[32:35], s74 offen offset:0 sc1
    v_add_f32 v234, v234, v235
    v_add_f32 v238, v238, v239
    s_nop 0
    v_permlane16_swap_b32 v232, v234
    v_permlane16_swap_b32 v236, v238
    buffer_load_dwordx4 v[124:127], v8, s[32:35], s74 offen offset:2048 sc1
    v_add_f32 v232, v232, v234
    s_add_u32 s73, s76, 8192
    v_add_f32 v236, v236, v238
    v_rcp_f32 v232, v232
    buffer_load_dwordx4 v[132:135], v8, s[32:35], s73 offen offset:0 sc1
    v_rcp_f32 v236, v236
    v_mov_b32 v234, v232
    v_mov_b32 v238, v236
    s_nop 0
    v_permlane16_swap_b32 v232, v234
    buffer_load_dwordx4 v[140:143], v8, s[32:35], s73 offen offset:2048 sc1
    v_permlane16_swap_b32 v236, v238
    s_add_u32 s74, s76, 12288
    v_mov_b32 v233, v232
    v_mov_b32 v237, v236
    buffer_load_dwordx4 v[148:151], v8, s[32:35], s74 offen offset:0 sc1
    v_mov_b32 v235, v234
    v_mov_b32 v239, v238
    v_permlane32_swap_b32 v232, v233
    v_permlane32_swap_b32 v236, v237
    buffer_load_dwordx4 v[156:159], v8, s[32:35], s74 offen offset:2048 sc1
    v_permlane32_swap_b32 v234, v235
    s_add_u32 s73, s76, 0
    v_permlane32_swap_b32 v238, v239
    buffer_load_dwordx4 v[104:107], v8, s[32:35], s73 offen offset:1024 sc1
    v_pk_mul_f32 v[216:217], v[216:217], v[232:233] op_sel:[0,0] op_sel_hi:[1,0]
    v_pk_mul_f32 v[68:69], v[68:69], v[236:237] op_sel:[0,0] op_sel_hi:[1,0]
    v_pk_mul_f32 v[218:219], v[218:219], v[232:233] op_sel:[0,0] op_sel_hi:[1,0]
    v_pk_mul_f32 v[70:71], v[70:71], v[236:237] op_sel:[0,0] op_sel_hi:[1,0]
    v_cvt_pk_bf16_f32 v240, v216, v217
    buffer_load_dwordx4 v[112:115], v8, s[32:35], s73 offen offset:3072 sc1
    v_cvt_pk_bf16_f32 v241, v218, v219
    s_add_u32 s74, s76, 4096
    v_cvt_pk_bf16_f32 v242, v68, v69
    v_cvt_pk_bf16_f32 v243, v70, v71
    v_pk_mul_f32 v[220:221], v[220:221], v[232:233] op_sel:[0,1] op_sel_hi:[1,1]
    buffer_load_dwordx4 v[120:123], v8, s[32:35], s74 offen offset:1024 sc1
    v_pk_mul_f32 v[72:73], v[72:73], v[236:237] op_sel:[0,1] op_sel_hi:[1,1]
    v_pk_mul_f32 v[222:223], v[222:223], v[232:233] op_sel:[0,1] op_sel_hi:[1,1]
    v_pk_mul_f32 v[74:75], v[74:75], v[236:237] op_sel:[0,1] op_sel_hi:[1,1]
    v_cvt_pk_bf16_f32 v244, v220, v221
    v_cvt_pk_bf16_f32 v245, v222, v223
    buffer_load_dwordx4 v[128:131], v8, s[32:35], s74 offen offset:3072 sc1
    v_cvt_pk_bf16_f32 v246, v72, v73
    s_add_u32 s73, s76, 8192
    v_cvt_pk_bf16_f32 v247, v74, v75
    v_pk_mul_f32 v[224:225], v[224:225], v[234:235] op_sel:[0,0] op_sel_hi:[1,0]
    v_pk_mul_f32 v[76:77], v[76:77], v[238:239] op_sel:[0,0] op_sel_hi:[1,0]
    buffer_load_dwordx4 v[136:139], v8, s[32:35], s73 offen offset:1024 sc1
    v_pk_mul_f32 v[226:227], v[226:227], v[234:235] op_sel:[0,0] op_sel_hi:[1,0]
    v_pk_mul_f32 v[78:79], v[78:79], v[238:239] op_sel:[0,0] op_sel_hi:[1,0]
    v_cvt_pk_bf16_f32 v248, v224, v225
    v_cvt_pk_bf16_f32 v249, v226, v227
    v_cvt_pk_bf16_f32 v250, v76, v77
    buffer_load_dwordx4 v[144:147], v8, s[32:35], s73 offen offset:3072 sc1
    v_cvt_pk_bf16_f32 v251, v78, v79
    s_add_u32 s74, s76, 12288
    v_pk_mul_f32 v[228:229], v[228:229], v[234:235] op_sel:[0,1] op_sel_hi:[1,1]
    v_pk_mul_f32 v[80:81], v[80:81], v[238:239] op_sel:[0,1] op_sel_hi:[1,1]
    v_pk_mul_f32 v[230:231], v[230:231], v[234:235] op_sel:[0,1] op_sel_hi:[1,1]
    buffer_load_dwordx4 v[152:155], v8, s[32:35], s74 offen offset:1024 sc1
    v_pk_mul_f32 v[82:83], v[82:83], v[238:239] op_sel:[0,1] op_sel_hi:[1,1]
    v_cvt_pk_bf16_f32 v252, v228, v229
    v_cvt_pk_bf16_f32 v253, v230, v231
    v_cvt_pk_bf16_f32 v254, v80, v81
    v_cvt_pk_bf16_f32 v255, v82, v83
    buffer_load_dwordx4 v[160:163], v8, s[32:35], s74 offen offset:3072 sc1
    s_lshl_b32 s18, s64, 7
    s_add_u32 s18, s18, 65536
    v_lshlrev_b32 v202, 10, v5
    buffer_load_dwordx2 v[200:201], v202, s[32:35], s18 offen sc1
    s_lshl_b32 s77, s66, 1
    s_add_u32 s77, s77, s93
    s_lshl_b32 s77, s77, 3
    s_add_u32 s77, s77, s67
    s_lshl_b32 s77, s77, 1
    s_add_u32 s77, s77, s92
    s_lshl_b32 s77, s77, 11
    s_add_u32 s77, s77, 7340032
    v_min_u32 v196, 15, v1
    v_lshlrev_b32 v196, 7, v196
    buffer_load_dword v197, v196, s[32:35], s77 offen sc1
    s_mov_b32 s78, 0
    v_mov_b32 v212, 0x3f80
    ds_read_b64_tr_b16 a[128:129], v20 offset:32768
    ds_read_b64_tr_b16 a[130:131], v20 offset:34816
    ds_read_b64_tr_b16 a[132:133], v21 offset:32768
    ds_read_b64_tr_b16 a[134:135], v21 offset:34816
    v_mov_b32 v167, 0
    ds_read_b64_tr_b16 a[136:137], v22 offset:32768
    ds_read_b64_tr_b16 a[138:139], v22 offset:34816
    ds_read_b64_tr_b16 a[140:141], v23 offset:32768
    ds_read_b64_tr_b16 a[142:143], v23 offset:34816
    v_mov_b32 v169, 0
    ds_read_b64_tr_b16 a[144:145], v20 offset:36864
    ds_read_b64_tr_b16 a[146:147], v20 offset:38912
    ds_read_b64_tr_b16 a[148:149], v21 offset:36864
    v_mov_b32 v165, 0
    ds_read_b64_tr_b16 a[150:151], v21 offset:38912
    ds_read_b64_tr_b16 a[152:153], v22 offset:36864
    ds_read_b64_tr_b16 a[154:155], v22 offset:38912
    ds_read_b64_tr_b16 a[156:157], v23 offset:36864
    v_cmp_eq_u32 s[80:81], 0, v3
    ds_read_b64_tr_b16 a[158:159], v23 offset:38912
    ds_read_b64_tr_b16 a[160:161], v20 offset:40960
    ds_read_b64_tr_b16 a[162:163], v20 offset:43008
    v_cmp_eq_u32 s[82:83], 1, v3
    ds_read_b64_tr_b16 a[164:165], v21 offset:40960
    ds_read_b64_tr_b16 a[166:167], v21 offset:43008
    ds_read_b64_tr_b16 a[168:169], v22 offset:40960
    ds_read_b64_tr_b16 a[170:171], v22 offset:43008
    v_cmp_gt_u32 s[84:85], 32, v1
    ds_read_b64_tr_b16 a[172:173], v23 offset:40960
    ds_read_b64_tr_b16 a[174:175], v23 offset:43008
    ds_read_b64_tr_b16 a[176:177], v20 offset:45056
    v_cndmask_b32 v166, 0, v212, s[80:81]
    ds_read_b64_tr_b16 a[178:179], v20 offset:47104
    ds_read_b64_tr_b16 a[180:181], v21 offset:45056
    ds_read_b64_tr_b16 a[182:183], v21 offset:47104
    ds_read_b64_tr_b16 a[184:185], v22 offset:45056
    v_cndmask_b32 v168, 0, v212, s[82:83]
    ds_read_b64_tr_b16 a[186:187], v22 offset:47104
    ds_read_b64_tr_b16 a[188:189], v23 offset:45056
    ds_read_b64_tr_b16 a[190:191], v23 offset:47104
    s_waitcnt vmcnt(16)
L_s_7:
    v_cmp_ne_u32 vcc, s70, v101
    v_cmp_ne_u32 s[86:87], s70, v109
    s_nop 0
    s_or_b64 vcc, vcc, s[86:87]
    s_cbranch_scc1 L_sr_9
L_sx_8:
    v_add_f32 v100, v100, v108
    s_waitcnt vmcnt(14)
L_s_10:
    v_cmp_ne_u32 vcc, s70, v117
    v_cmp_ne_u32 s[86:87], s70, v125
    s_nop 0
    s_or_b64 vcc, vcc, s[86:87]
    s_cbranch_scc1 L_sr_12
L_sx_11:
    v_add_f32 v116, v116, v124
    v_add_f32 v100, v100, v116
    s_waitcnt vmcnt(12)
L_s_13:
    v_cmp_ne_u32 vcc, s70, v133
    v_cmp_ne_u32 s[86:87], s70, v141
    s_nop 0
    s_or_b64 vcc, vcc, s[86:87]
    s_cbranch_scc1 L_sr_15
L_sx_14:
    v_add_f32 v132, v132, v140
    v_add_f32 v100, v100, v132
    s_waitcnt vmcnt(10)
L_s_16:
    v_cmp_ne_u32 vcc, s70, v149
    v_cmp_ne_u32 s[86:87], s70, v157
    s_nop 0
    s_or_b64 vcc, vcc, s[86:87]
    s_cbranch_scc1 L_sr_18
L_sx_17:
    v_add_f32 v148, v148, v156
    v_add_f32 v100, v100, v148
    v_cvt_pk_bf16_f32 v164, v100, 0
    v_cndmask_b32 v164, 0, v164, s[84:85]
    s_nop 1
    v_mfma_f32_16x16x16_bf16 v[172:175], v[164:165], v[166:167], 0
    v_mfma_f32_16x16x16_bf16 v[176:179], v[164:165], v[168:169], 0
    s_waitcnt vmcnt(8)
L_s_19:
    v_cmp_ne_u32 vcc, s70, v107
    v_cmp_ne_u32 s[86:87], s70, v115
    s_nop 0
    s_or_b64 vcc, vcc, s[86:87]
    s_cbranch_scc1 L_sr_21
L_sx_20:
    s_nop 0
    v_cvt_pk_bf16_f32 v180, v172, v173
    v_cvt_pk_bf16_f32 v181, v174, v175
    v_cvt_pk_bf16_f32 v182, v176, v177
    v_cvt_pk_bf16_f32 v183, v178, v179
    v_mfma_f32_16x16x32_bf16 v[52:55], v[102:105], v[240:243], 0
    buffer_load_dwordx4 v10, s[40:43], s79 offen offset:1024 lds
    s_lshr_b32 s77, s69, 1
    v_mfma_f32_16x16x32_bf16 v[56:59], v[102:105], v[244:247], 0
    s_mul_i32 s17, s66, 172
    s_add_u32 s77, s77, s17
    v_mfma_f32_16x16x32_bf16 v[60:63], v[102:105], v[248:251], 0
    s_lshl_b32 s77, s77, 10
    s_add_u32 s77, s77, 10485760
    v_mfma_f32_16x16x32_bf16 v[64:67], v[102:105], v[252:255], 0
    s_mul_i32 s13, s93, 88064
    s_lshl_b32 s17, s92, 14
    v_mfma_f32_16x16x32_bf16 v[84:87], v[180:183], v[240:243], 0
    v_mfma_f32_16x16x32_bf16 v[88:91], v[180:183], v[244:247], 0
    v_mfma_f32_16x16x32_bf16 v[92:95], v[180:183], v[248:251], 0
    buffer_load_dwordx4 v11, s[40:43], s79 offen offset:2048 lds
    v_mfma_f32_16x16x32_bf16 v[96:99], v[180:183], v[252:255], 0
    v_mfma_f32_16x16x32_bf16 v[52:55], v[110:113], v[240:243], v[52:55]
    v_mfma_f32_16x16x32_bf16 v[56:59], v[110:113], v[244:247], v[56:59]
    v_mfma_f32_16x16x32_bf16 v[60:63], v[110:113], v[248:251], v[60:63]
    s_sub_u32 s79, 880640, s15
    s_add_u32 m0, s95, 126976
    v_mfma_f32_16x16x32_bf16 v[64:67], v[110:113], v[252:255], v[64:67]
    s_waitcnt vmcnt(8)
L_s_22:
    v_cmp_ne_u32 vcc, s70, v123
    v_cmp_ne_u32 s[86:87], s70, v131
    s_nop 0
    s_or_b64 vcc, vcc, s[86:87]
    s_cbranch_scc1 L_sr_24
L_sx_23:
    v_mfma_f32_16x16x32_bf16 v[52:55], v[118:121], v[240:243], v[52:55]
    buffer_load_dwordx4 v9, s[40:43], s79 offen offset:0 lds
    v_add_f32 v84, 0x358637bd, v84
    v_mfma_f32_16x16x32_bf16 v[56:59], v[118:121], v[244:247], v[56:59]
    v_add_f32 v88, 0x358637bd, v88
    v_add_f32 v92, 0x358637bd, v92
    v_mfma_f32_16x16x32_bf16 v[60:63], v[118:121], v[248:251], v[60:63]
    v_add_f32 v96, 0x358637bd, v96
    v_mfma_f32_16x16x32_bf16 v[64:67], v[118:121], v[252:255], v[64:67]
    v_rcp_f32 v84, v84
    v_mfma_f32_16x16x32_bf16 v[52:55], v[126:129], v[240:243], v[52:55]
    v_rcp_f32 v88, v88
    v_mfma_f32_16x16x32_bf16 v[56:59], v[126:129], v[244:247], v[56:59]
    v_rcp_f32 v92, v92
    v_mfma_f32_16x16x32_bf16 v[60:63], v[126:129], v[248:251], v[60:63]
    buffer_load_dwordx4 v10, s[40:43], s79 offen offset:1024 lds
    v_mfma_f32_16x16x32_bf16 v[64:67], v[126:129], v[252:255], v[64:67]
    v_rcp_f32 v96, v96
    s_sub_u32 s74, 88064, s13
    s_add_u32 s13, s13, s77
    s_add_u32 s74, s74, s77
    s_xor_b32 s77, s17, 16384
    s_add_u32 s14, s13, s77
    s_add_u32 s75, s74, s77
    s_add_u32 s13, s13, s17
    s_waitcnt vmcnt(8)
L_s_25:
    v_cmp_ne_u32 vcc, s70, v139
    v_cmp_ne_u32 s[86:87], s70, v147
    s_nop 0
    s_or_b64 vcc, vcc, s[86:87]
    s_cbranch_scc1 L_sr_27
L_sx_26:
    v_mfma_f32_16x16x32_bf16 v[52:55], v[134:137], v[240:243], v[52:55]
    s_add_u32 s74, s74, s17
    s_lshl_b32 s77, s92, 3
    v_mfma_f32_16x16x32_bf16 v[56:59], v[134:137], v[244:247], v[56:59]
    v_add_u32 v4, s77, v8
    v_xor_b32 v220, v2, v3
    v_mfma_f32_16x16x32_bf16 v[60:63], v[134:137], v[248:251], v[60:63]
    v_and_b32 v220, 1, v220
    v_cmp_eq_u32 s[80:81], 0, v220
    v_mfma_f32_16x16x32_bf16 v[64:67], v[134:137], v[252:255], v[64:67]
    s_mul_i32 s77, s3, 24576
    v_mfma_f32_16x16x32_bf16 v[52:55], v[142:145], v[240:243], v[52:55]
    buffer_load_dwordx4 v11, s[40:43], s79 offen offset:2048 lds
    v_mfma_f32_16x16x32_bf16 v[56:59], v[142:145], v[244:247], v[56:59]
    v_mfma_f32_16x16x32_bf16 v[60:63], v[142:145], v[248:251], v[60:63]
    v_mfma_f32_16x16x32_bf16 v[64:67], v[142:145], v[252:255], v[64:67]
    s_waitcnt vmcnt(7)
L_s_28:
    v_cmp_ne_u32 vcc, s70, v155
    v_cmp_ne_u32 s[86:87], s70, v163
    s_nop 0
    s_or_b64 vcc, vcc, s[86:87]
    s_cbranch_scc1 L_sr_30
L_sx_29:
    v_mfma_f32_16x16x32_bf16 v[52:55], v[150:153], v[240:243], v[52:55]
    s_sub_u32 s79, 1056768, s15
    s_add_u32 m0, s95, 139264
    v_mfma_f32_16x16x32_bf16 v[56:59], v[150:153], v[244:247], v[56:59]
    v_add_u32 v17, s77, v18
    v_cndmask_b32 v220, 0, v32, s[80:81]
    v_mfma_f32_16x16x32_bf16 v[60:63], v[150:153], v[248:251], v[60:63]
    buffer_load_dwordx4 v9, s[40:43], s79 offen offset:0 lds
    v_mov_b32 v221, v220
    v_mfma_f32_16x16x32_bf16 v[64:67], v[150:153], v[252:255], v[64:67]
    v_mov_b32 v222, v220
    v_mov_b32 v223, v220
    v_mfma_f32_16x16x32_bf16 v[52:55], v[158:161], v[240:243], v[52:55]
    v_mfma_f32_16x16x32_bf16 v[56:59], v[158:161], v[244:247], v[56:59]
    v_mfma_f32_16x16x32_bf16 v[60:63], v[158:161], v[248:251], v[60:63]
    v_mfma_f32_16x16x32_bf16 v[64:67], v[158:161], v[252:255], v[64:67]
    s_waitcnt vmcnt(7)
    s_mov_b32 s78, 0
L_xc_1:
    v_cmp_ne_u32 vcc, s70, v200
    v_cmp_ne_u32 s[80:81], s71, v201
    s_cbranch_vccnz L_xcr_3
L_xcx_2:
    s_or_b64 vcc, vcc, s[80:81]
    s_cmp_eq_u64 vcc, 0
    s_cselect_b32 s71, 1, 0
    v_pk_mul_f32 v[52:53], v[52:53], v[84:85] op_sel_hi:[1,0]
    v_pk_mul_f32 v[54:55], v[54:55], v[84:85] op_sel_hi:[1,0]
    v_cvt_pk_bf16_f32 v184, v52, v53
    v_cvt_pk_bf16_f32 v185, v54, v55
    v_pk_mul_f32 v[56:57], v[56:57], v[88:89] op_sel_hi:[1,0]
    v_pk_mul_f32 v[58:59], v[58:59], v[88:89] op_sel_hi:[1,0]
    v_cvt_pk_bf16_f32 v186, v56, v57
    v_cvt_pk_bf16_f32 v187, v58, v59
    v_pk_mul_f32 v[60:61], v[60:61], v[92:93] op_sel_hi:[1,0]
    v_pk_mul_f32 v[62:63], v[62:63], v[92:93] op_sel_hi:[1,0]
    v_cvt_pk_bf16_f32 v188, v60, v61
    v_cvt_pk_bf16_f32 v189, v62, v63
    v_pk_mul_f32 v[64:65], v[64:65], v[96:97] op_sel_hi:[1,0]
    v_pk_mul_f32 v[66:67], v[66:67], v[96:97] op_sel_hi:[1,0]
    v_cvt_pk_bf16_f32 v190, v64, v65
    v_cvt_pk_bf16_f32 v191, v66, v67
    s_cmp_eq_u32 s71, 0
    s_cbranch_scc1 L_slow_31
    buffer_store_dwordx2 v[184:185], v4, s[32:35], s13 offen
    buffer_store_dwordx2 v[186:187], v4, s[32:35], s14 offen
    buffer_store_dwordx2 v[188:189], v4, s[32:35], s74 offen
    buffer_store_dwordx2 v[190:191], v4, s[32:35], s75 offen
L_join_32:
    s_lshl_b32 s76, s66, 7
    s_add_u32 s76, s76, 12288
    s_lshl_b32 s73, s69, 2
    s_add_u32 s73, s73, s76
    v_lshlrev_b32 v4, 2, v1
    ds_read_b64_tr_b16 a[192:193], v20 offset:49152
    ds_read_b64_tr_b16 a[194:195], v20 offset:51200
    ds_read_b64_tr_b16 a[196:197], v21 offset:49152
    ds_read_b64_tr_b16 a[198:199], v21 offset:51200
    ds_read_b64_tr_b16 a[200:201], v22 offset:49152
    ds_read_b64_tr_b16 a[202:203], v22 offset:51200
    ds_read_b64_tr_b16 a[204:205], v23 offset:49152
    ds_read_b64_tr_b16 a[206:207], v23 offset:51200
    ds_read_b64_tr_b16 a[208:209], v20 offset:53248
    ds_read_b64_tr_b16 a[210:211], v20 offset:55296
    ds_read_b64_tr_b16 a[212:213], v21 offset:53248
    ds_read_b64_tr_b16 a[214:215], v21 offset:55296
    ds_read_b64_tr_b16 a[216:217], v22 offset:53248
    ds_read_b64_tr_b16 a[218:219], v22 offset:55296
    ds_read_b64_tr_b16 a[220:221], v23 offset:53248
    ds_read_b64_tr_b16 a[222:223], v23 offset:55296
    ds_read_b64_tr_b16 a[224:225], v20 offset:57344
    ds_read_b64_tr_b16 a[226:227], v20 offset:59392
    ds_read_b64_tr_b16 a[228:229], v21 offset:57344
    ds_read_b64_tr_b16 a[230:231], v21 offset:59392
    ds_read_b64_tr_b16 a[232:233], v22 offset:57344
    ds_read_b64_tr_b16 a[234:235], v22 offset:59392
    ds_read_b64_tr_b16 a[236:237], v23 offset:57344
    ds_read_b64_tr_b16 a[238:239], v23 offset:59392
    ds_read_b64_tr_b16 a[240:241], v20 offset:61440
    ds_read_b64_tr_b16 a[242:243], v20 offset:63488
    ds_read_b64_tr_b16 a[244:245], v21 offset:61440
    ds_read_b64_tr_b16 a[246:247], v21 offset:63488
    ds_read_b64_tr_b16 a[248:249], v22 offset:61440
    ds_read_b64_tr_b16 a[250:251], v22 offset:63488
    ds_read_b64_tr_b16 a[252:253], v23 offset:61440
    ds_read_b64_tr_b16 a[254:255], v23 offset:63488
    v_mov_b32 v209, s70
    v_mov_b32 v208, 0
    s_waitcnt vmcnt(0)
    s_mov_b64 exec, 1
    s_cmp_eq_u32 s71, 0
    s_cbranch_scc1 L_slow_33
    buffer_store_dword v209, v208, s[32:35], s73 offen
L_join_34:
    s_mov_b64 exec, -1
    s_waitcnt lgkmcnt(0)
    s_lshl_b32 s77, s66, 1
    s_add_u32 s77, s77, s93
    s_mul_i32 s77, s77, 88064
    s_lshl_b32 s73, s92, 14
    s_add_u32 s77, s77, s73
    s_add_u32 s77, s77, 10485760
    v_lshrrev_b32 v24, 3, v1
    v_lshlrev_b32 v24, 10, v24
    v_lshrrev_b32 v20, 2, v1
    v_xor_b32 v20, v20, v3
    v_and_b32 v20, 1, v20
    v_lshl_add_u32 v24, v20, 6, v24
    v_and_b32 v20, 3, v1
    v_lshl_add_u32 v20, v20, 4, v24
    v_add_u32 v21, 7168, v20
    v_add_u32 v22, 14336, v20
    v_add_u32 v23, 21504, v20
    v_lshlrev_b32 v212, 2, v5
    v_lshlrev_b32 v192, 16, v36
    v_and_b32 v193, 0xffff0000, v36
    v_lshlrev_b32 v194, 16, v37
    v_and_b32 v195, 0xffff0000, v37
    v_lshlrev_b32 v196, 16, v38
    v_and_b32 v197, 0xffff0000, v38
    v_lshlrev_b32 v198, 16, v39
    v_and_b32 v199, 0xffff0000, v39
    v_lshlrev_b32 v200, 16, v40
    v_and_b32 v201, 0xffff0000, v40
    v_lshlrev_b32 v202, 16, v41
    v_and_b32 v203, 0xffff0000, v41
    v_lshlrev_b32 v204, 16, v42
    v_and_b32 v205, 0xffff0000, v42
    v_lshlrev_b32 v206, 16, v43
    v_and_b32 v207, 0xffff0000, v43
    s_lshl_b32 s75, s66, 1
    s_add_u32 s75, s75, s93
    s_lshl_b32 s73, s75, 15
    s_lshl_b32 s17, s67, 12
    s_add_u32 s73, s73, s17
    s_lshl_b32 s17, s92, 8
    s_add_u32 s73, s73, s17
    s_add_u32 s73, s73, 7340032
    s_lshl_b32 s74, s75, 11
    s_add_u32 s74, s74, s17
    s_lshr_b32 s17, s67, 2
    s_lshl_b32 s17, s17, 10
    s_add_u32 s74, s74, s17
    s_and_b32 s17, s67, 3
    s_lshl_b32 s17, s17, 2
    s_add_u32 s74, s74, s17
    s_add_u32 s74, s74, 9437184
    s_lshl_b32 s75, s75, 7
    s_lshl_b32 s17, s67, 3
    s_add_u32 s75, s75, s17
    s_lshl_b32 s17, s92, 2
    s_add_u32 s75, s75, s17
    s_add_u32 s75, s75, 16384
    v_lshlrev_b32 v13, 9, v6
    v_lshl_add_u32 v13, v2, 4, v13
    v_lshl_add_u32 v14, v7, 10, v13
    s_mov_b64 s[48:49], s[32:33]
    s_mul_i32 s78, s66, 176128
    s_add_u32 s78, s78, 10485760
    s_add_u32 s48, s48, s78
    s_addc_u32 s49, s49, 0
    s_and_b32 s49, s49, 0xffff
    s_mov_b32 s50, 88064
    s_mov_b32 s51, 0x20000
    s_mov_b64 s[52:53], s[32:33]
    s_mul_i32 s78, s66, 176128
    s_add_u32 s78, s78, 10573824
    s_add_u32 s52, s52, s78
    s_addc_u32 s53, s53, 0
    s_and_b32 s53, s53, 0xffff
    s_mov_b32 s54, 88064
    s_mov_b32 s55, 0x20000
    s_add_u32 s17, s19, 4293558272
    s_min_u32 s25, s25, s17
    s_add_u32 s26, s19, 65536
    s_add_u32 s17, s19, 4293591040
    s_min_u32 s26, s26, s17
    s_add_u32 s27, s19, 98304
    buffer_load_dword v208, v212, s[32:35], s76 offen sc1
    s_add_u32 s17, s19, 4293623808
    s_min_u32 s27, s27, s17
    s_add_u32 s28, s19, 131072
    s_add_u32 s17, s19, 4293656576
    s_min_u32 s28, s28, s17
    s_add_u32 s29, s19, 163840
    s_add_u32 s17, s19, 4293689344
    s_min_u32 s29, s29, s17
    s_add_u32 s30, s19, 180224
    s_add_u32 s17, s19, 4293705728
    s_min_u32 s30, s30, s17
    s_add_u32 s31, s19, 212992
    s_add_u32 s17, s19, 4293738496
    s_min_u32 s31, s31, s17
    s_add_u32 s60, s19, 229376
    s_add_u32 s17, s19, 4293754880
    s_min_u32 s60, s60, s17
    s_add_u32 s61, s19, 262144
    s_add_u32 s17, s19, 4293787648
    s_min_u32 s61, s61, s17
    s_add_u32 s62, s19, 278528
    s_add_u32 s17, s19, 4293804032
    s_min_u32 s62, s62, s17
    s_add_u32 s63, s19, 311296
    s_add_u32 s17, s19, 4293836800
    s_min_u32 s63, s63, s17
    s_add_u32 s12, s19, 327680
    s_add_u32 s17, s19, 4293853184
    s_min_u32 s12, s12, s17
    s_mov_b32 s78, 0
L_f2_35:
    s_waitcnt vmcnt(0)
    v_cmp_ne_u32 vcc, s70, v208
    s_cbranch_vccz L_f2x_36
    s_add_u32 s78, s78, 1
    s_cmp_lt_u32 s78, 60000
    s_cbranch_scc0 L_f2x_36
    buffer_load_dword v208, v212, s[32:35], s76 offen sc1
    s_branch L_f2_35
L_f2x_36:
    s_add_u32 s79, s77, 0
    buffer_load_dwordx4 v[68:71], v8, s[32:35], s79 offen offset:0 sc1
    buffer_load_dwordx4 v[72:75], v8, s[32:35], s79 offen offset:1024 sc1
    buffer_load_dwordx4 v[76:79], v8, s[32:35], s79 offen offset:2048 sc1
    buffer_load_dwordx4 v[80:83], v8, s[32:35], s79 offen offset:3072 sc1
    s_add_u32 s79, s77, 4096
    buffer_load_dwordx4 v[84:87], v8, s[32:35], s79 offen offset:0 sc1
    buffer_load_dwordx4 v[88:91], v8, s[32:35], s79 offen offset:1024 sc1
    buffer_load_dwordx4 v[92:95], v8, s[32:35], s79 offen offset:2048 sc1
    s_waitcnt lgkmcnt(0)
    s_barrier
    s_waitcnt vmcnt(6)
    v_mfma_f32_16x16x32_bf16 v[52:55], a[0:3], v[68:71], 0
    buffer_load_dwordx4 v[96:99], v8, s[32:35], s79 offen offset:3072 sc1
    v_mfma_f32_16x16x32_bf16 v[56:59], a[4:7], v[68:71], 0
    v_mfma_f32_16x16x32_bf16 v[60:63], a[8:11], v[68:71], 0
    v_mfma_f32_16x16x32_bf16 v[64:67], a[12:15], v[68:71], 0
    s_waitcnt vmcnt(6)
    v_mfma_f32_16x16x32_bf16 v[52:55], a[16:19], v[72:75], v[52:55]
    s_add_u32 s79, s77, 8192
    buffer_load_dwordx4 v[100:103], v8, s[32:35], s79 offen offset:0 sc1
    v_mfma_f32_16x16x32_bf16 v[56:59], a[20:23], v[72:75], v[56:59]
    v_mfma_f32_16x16x32_bf16 v[60:63], a[24:27], v[72:75], v[60:63]
    v_mfma_f32_16x16x32_bf16 v[64:67], a[28:31], v[72:75], v[64:67]
    s_waitcnt vmcnt(6)
    v_mfma_f32_16x16x32_bf16 v[52:55], a[32:35], v[76:79], v[52:55]
    buffer_load_dwordx4 v[104:107], v8, s[32:35], s79 offen offset:1024 sc1
    v_mfma_f32_16x16x32_bf16 v[56:59], a[36:39], v[76:79], v[56:59]
    v_mfma_f32_16x16x32_bf16 v[60:63], a[40:43], v[76:79], v[60:63]
    v_mfma_f32_16x16x32_bf16 v[64:67], a[44:47], v[76:79], v[64:67]
    s_waitcnt vmcnt(6)
    v_mfma_f32_16x16x32_bf16 v[52:55], a[48:51], v[80:83], v[52:55]
    buffer_load_dwordx4 v[108:111], v8, s[32:35], s79 offen offset:2048 sc1
    v_mfma_f32_16x16x32_bf16 v[56:59], a[52:55], v[80:83], v[56:59]
    v_mfma_f32_16x16x32_bf16 v[60:63], a[56:59], v[80:83], v[60:63]
    v_mfma_f32_16x16x32_bf16 v[64:67], a[60:63], v[80:83], v[64:67]
    s_waitcnt vmcnt(6)
    v_mfma_f32_16x16x32_bf16 v[52:55], a[64:67], v[84:87], v[52:55]
    buffer_load_dwordx4 v[112:115], v8, s[32:35], s79 offen offset:3072 sc1
    v_mfma_f32_16x16x32_bf16 v[56:59], a[68:71], v[84:87], v[56:59]
    v_mfma_f32_16x16x32_bf16 v[60:63], a[72:75], v[84:87], v[60:63]
    v_mfma_f32_16x16x32_bf16 v[64:67], a[76:79], v[84:87], v[64:67]
    s_waitcnt vmcnt(6)
    v_mfma_f32_16x16x32_bf16 v[52:55], a[80:83], v[88:91], v[52:55]
    s_add_u32 s79, s77, 12288
    buffer_load_dwordx4 v[116:119], v8, s[32:35], s79 offen offset:0 sc1
    v_mfma_f32_16x16x32_bf16 v[56:59], a[84:87], v[88:91], v[56:59]
    v_mfma_f32_16x16x32_bf16 v[60:63], a[88:91], v[88:91], v[60:63]
    v_mfma_f32_16x16x32_bf16 v[64:67], a[92:95], v[88:91], v[64:67]
    s_waitcnt vmcnt(6)
    v_mfma_f32_16x16x32_bf16 v[52:55], a[96:99], v[92:95], v[52:55]
    buffer_load_dwordx4 v[120:123], v8, s[32:35], s79 offen offset:1024 sc1
    v_mfma_f32_16x16x32_bf16 v[56:59], a[100:103], v[92:95], v[56:59]
    v_mfma_f32_16x16x32_bf16 v[60:63], a[104:107], v[92:95], v[60:63]
    v_mfma_f32_16x16x32_bf16 v[64:67], a[108:111], v[92:95], v[64:67]
    s_waitcnt vmcnt(6)
    v_mfma_f32_16x16x32_bf16 v[52:55], a[112:115], v[96:99], v[52:55]
    buffer_load_dwordx4 v[124:127], v8, s[32:35], s79 offen offset:2048 sc1
    v_mfma_f32_16x16x32_bf16 v[56:59], a[116:119], v[96:99], v[56:59]
    v_mfma_f32_16x16x32_bf16 v[60:63], a[120:123], v[96:99], v[60:63]
    v_mfma_f32_16x16x32_bf16 v[64:67], a[124:127], v[96:99], v[64:67]
    s_waitcnt vmcnt(6)
    v_mfma_f32_16x16x32_bf16 v[52:55], a[128:131], v[100:103], v[52:55]
    buffer_load_dwordx4 v[128:131], v8, s[32:35], s79 offen offset:3072 sc1
    v_mfma_f32_16x16x32_bf16 v[56:59], a[132:135], v[100:103], v[56:59]
    v_mfma_f32_16x16x32_bf16 v[60:63], a[136:139], v[100:103], v[60:63]
    v_mfma_f32_16x16x32_bf16 v[64:67], a[140:143], v[100:103], v[64:67]
    s_waitcnt vmcnt(6)
    v_mfma_f32_16x16x32_bf16 v[52:55], a[144:147], v[104:107], v[52:55]
    s_sub_u32 s17, 1056768, s15
    s_add_u32 m0, s95, 139264
    s_nop 0
    buffer_load_dwordx4 v10, s[40:43], s17 offen offset:1024 lds
    v_mfma_f32_16x16x32_bf16 v[56:59], a[148:151], v[104:107], v[56:59]
    buffer_load_dwordx4 v11, s[40:43], s17 offen offset:2048 lds
    v_mfma_f32_16x16x32_bf16 v[60:63], a[152:155], v[104:107], v[60:63]
    v_mfma_f32_16x16x32_bf16 v[64:67], a[156:159], v[104:107], v[64:67]
    s_waitcnt vmcnt(7)
    v_mfma_f32_16x16x32_bf16 v[52:55], a[160:163], v[108:111], v[52:55]
    s_sub_u32 s17, 1232896, s15
    s_add_u32 m0, s95, 151552
    s_nop 0
    buffer_load_dwordx4 v9, s[40:43], s17 offen offset:0 lds
    v_mfma_f32_16x16x32_bf16 v[56:59], a[164:167], v[108:111], v[56:59]
    buffer_load_dwordx4 v10, s[40:43], s17 offen offset:1024 lds
    v_mfma_f32_16x16x32_bf16 v[60:63], a[168:171], v[108:111], v[60:63]
    v_mfma_f32_16x16x32_bf16 v[64:67], a[172:175], v[108:111], v[64:67]
    s_waitcnt vmcnt(8)
    v_mfma_f32_16x16x32_bf16 v[52:55], a[176:179], v[112:115], v[52:55]
    buffer_load_dwordx4 v11, s[40:43], s17 offen offset:2048 lds
    v_mfma_f32_16x16x32_bf16 v[56:59], a[180:183], v[112:115], v[56:59]
    s_add_u32 m0, s20, 0
    s_nop 0
    buffer_load_dwordx4 v20, s[44:47], s24 offen offset:0 lds
    v_mfma_f32_16x16x32_bf16 v[60:63], a[184:187], v[112:115], v[60:63]
    v_mfma_f32_16x16x32_bf16 v[64:67], a[188:191], v[112:115], v[64:67]
    s_waitcnt vmcnt(9)
    v_mfma_f32_16x16x32_bf16 v[52:55], a[192:195], v[116:119], v[52:55]
    buffer_load_dwordx4 v21, s[44:47], s24 offen offset:1024 lds
    v_mfma_f32_16x16x32_bf16 v[56:59], a[196:199], v[116:119], v[56:59]
    buffer_load_dwordx4 v22, s[44:47], s24 offen offset:2048 lds
    v_mfma_f32_16x16x32_bf16 v[60:63], a[200:203], v[116:119], v[60:63]
    v_mfma_f32_16x16x32_bf16 v[64:67], a[204:207], v[116:119], v[64:67]
    s_waitcnt vmcnt(10)
    v_mfma_f32_16x16x32_bf16 v[52:55], a[208:211], v[120:123], v[52:55]
    buffer_load_dwordx4 v23, s[44:47], s24 offen offset:3072 lds
    v_mfma_f32_16x16x32_bf16 v[56:59], a[212:215], v[120:123], v[56:59]
    v_mfma_f32_16x16x32_bf16 v[60:63], a[216:219], v[120:123], v[60:63]
    v_mfma_f32_16x16x32_bf16 v[64:67], a[220:223], v[120:123], v[64:67]
    s_waitcnt vmcnt(10)
    v_mfma_f32_16x16x32_bf16 v[52:55], a[224:227], v[124:127], v[52:55]
    v_mfma_f32_16x16x32_bf16 v[56:59], a[228:231], v[124:127], v[56:59]
    v_mfma_f32_16x16x32_bf16 v[60:63], a[232:235], v[124:127], v[60:63]
    v_mfma_f32_16x16x32_bf16 v[64:67], a[236:239], v[124:127], v[64:67]
    s_waitcnt vmcnt(9)
    v_mfma_f32_16x16x32_bf16 v[52:55], a[240:243], v[128:131], v[52:55]
    v_mfma_f32_16x16x32_bf16 v[56:59], a[244:247], v[128:131], v[56:59]
    v_mfma_f32_16x16x32_bf16 v[60:63], a[248:251], v[128:131], v[60:63]
    v_mfma_f32_16x16x32_bf16 v[64:67], a[252:255], v[128:131], v[64:67]
    s_nop 4
    v_pk_add_f32 v[176:177], v[52:53], v[192:193]
    v_pk_add_f32 v[178:179], v[54:55], v[194:195]
    v_pk_add_f32 v[180:181], v[56:57], v[196:197]
    v_pk_add_f32 v[182:183], v[58:59], v[198:199]
    v_pk_add_f32 v[184:185], v[60:61], v[200:201]
    v_pk_add_f32 v[186:187], v[62:63], v[202:203]
    v_pk_add_f32 v[188:189], v[64:65], v[204:205]
    v_pk_add_f32 v[190:191], v[66:67], v[206:207]
    v_cvt_pk_bf16_f32 v36, v176, v177
    v_cvt_pk_bf16_f32 v37, v178, v179
    v_cvt_pk_bf16_f32 v38, v180, v181
    v_cvt_pk_bf16_f32 v39, v182, v183
    v_cvt_pk_bf16_f32 v40, v184, v185
    v_cvt_pk_bf16_f32 v41, v186, v187
    v_cvt_pk_bf16_f32 v42, v188, v189
    v_cvt_pk_bf16_f32 v43, v190, v191
    v_permlane16_swap_b32 v36, v38
    v_permlane16_swap_b32 v37, v39
    v_permlane16_swap_b32 v40, v42
    v_permlane16_swap_b32 v41, v43
    s_cmp_eq_u32 s71, 0
    s_cbranch_scc1 L_slow_38
    buffer_store_dwordx4 v[36:39], v14, s[32:35], s73 offen offset:0
    buffer_store_dwordx4 v[40:43], v14, s[32:35], s73 offen offset:2048
L_join_39:
    v_pk_add_f32 v[208:209], v[176:177], v[178:179]
    v_pk_mul_f32 v[210:211], v[176:177], v[176:177]
    v_pk_fma_f32 v[210:211], v[178:179], v[178:179], v[210:211]
    v_pk_add_f32 v[208:209], v[208:209], v[180:181]
    v_pk_fma_f32 v[210:211], v[180:181], v[180:181], v[210:211]
    v_pk_add_f32 v[208:209], v[208:209], v[182:183]
    v_pk_fma_f32 v[210:211], v[182:183], v[182:183], v[210:211]
    v_pk_add_f32 v[208:209], v[208:209], v[184:185]
    v_pk_fma_f32 v[210:211], v[184:185], v[184:185], v[210:211]
    v_pk_add_f32 v[208:209], v[208:209], v[186:187]
    v_pk_fma_f32 v[210:211], v[186:187], v[186:187], v[210:211]
    v_pk_add_f32 v[208:209], v[208:209], v[188:189]
    v_pk_fma_f32 v[210:211], v[188:189], v[188:189], v[210:211]
    v_pk_add_f32 v[208:209], v[208:209], v[190:191]
    v_pk_fma_f32 v[210:211], v[190:191], v[190:191], v[210:211]
    v_add_f32 v208, v208, v209
    v_add_f32 v210, v210, v211
    s_nop 1
    v_permlane32_swap_b32 v208, v210
    v_add_f32 v208, v208, v210
    v_mov_b32 v210, v208
    s_nop 1
    v_permlane16_swap_b32 v208, v210
    v_add_f32 v208, v208, v210
    s_cmp_eq_u32 s71, 0
    s_cbranch_scc1 L_slow_40
    buffer_store_dword v208, v13, s[32:35], s74 offen
L_join_41:
    v_mov_b32 v213, s70
    v_mov_b32 v212, 0
    s_waitcnt vmcnt(0)
    s_mov_b64 exec, 1
    s_cmp_eq_u32 s71, 0
    s_cbranch_scc1 L_slow_42
    buffer_store_dword v213, v212, s[32:35], s75 offen
L_join_43:
    s_mov_b64 exec, -1
    s_add_u32 m0, s20, 4096
    s_nop 0
    buffer_load_dwordx4 v20, s[44:47], s25 offen offset:0 lds
    buffer_load_dwordx4 v21, s[44:47], s25 offen offset:1024 lds
    buffer_load_dwordx4 v22, s[44:47], s25 offen offset:2048 lds
    buffer_load_dwordx4 v23, s[44:47], s25 offen offset:3072 lds
    s_lshl_b32 s76, s90, 7
    s_add_u32 s76, s76, 16384
    s_lshl_b32 s77, s90, 15
    s_add_u32 s77, s77, 7340032
    s_cmp_lg_u32 s15, 0
    s_cselect_b32 s18, 16384, 0
    s_add_u32 s77, s77, s18
    s_xor_b32 s18, s77, 16384
    s_lshl_b32 s73, s90, 11
    s_add_u32 s73, s73, 9437184
    s_cmp_ge_u32 s65, 30
    s_cbranch_scc1 L_idle3
    s_barrier
    v_lshlrev_b32 v227, 2, v2
    ds_read_b64_tr_b16 v[100:101], v18 offset:0
    ds_read_b64_tr_b16 v[102:103], v18 offset:768
    ds_read_b64_tr_b16 v[104:105], v18 offset:64
    ds_read_b64_tr_b16 v[106:107], v18 offset:832
    ds_read_b64_tr_b16 v[108:109], v18 offset:128
    ds_read_b64_tr_b16 v[110:111], v18 offset:896
    ds_read_b64_tr_b16 v[112:113], v18 offset:3072
    ds_read_b64_tr_b16 v[114:115], v18 offset:3840
    ds_read_b64_tr_b16 v[116:117], v18 offset:3136
    ds_read_b64_tr_b16 v[118:119], v18 offset:3904
    ds_read_b64_tr_b16 v[120:121], v18 offset:3200
    ds_read_b64_tr_b16 v[122:123], v18 offset:3968
    ds_read_b64_tr_b16 v[124:125], v17 offset:0
    ds_read_b64_tr_b16 v[126:127], v17 offset:768
    ds_read_b64_tr_b16 v[128:129], v17 offset:64
    ds_read_b64_tr_b16 v[130:131], v17 offset:832
    ds_read_b64_tr_b16 v[132:133], v17 offset:128
    ds_read_b64_tr_b16 v[134:135], v17 offset:896
    ds_read_b64_tr_b16 v[136:137], v17 offset:3072
    ds_read_b64_tr_b16 v[138:139], v17 offset:3840
    ds_read_b64_tr_b16 v[140:141], v17 offset:3136
    ds_read_b64_tr_b16 v[142:143], v17 offset:3904
    ds_read_b64_tr_b16 v[144:145], v17 offset:3200
    ds_read_b64_tr_b16 v[146:147], v17 offset:3968
    ds_read_b64_tr_b16 v[148:149], v17 offset:6144
    ds_read_b64_tr_b16 v[150:151], v17 offset:6912
    ds_read_b64_tr_b16 v[152:153], v17 offset:6208
    ds_read_b64_tr_b16 v[154:155], v17 offset:6976
    ds_read_b64_tr_b16 v[156:157], v17 offset:6272
    ds_read_b64_tr_b16 v[158:159], v17 offset:7040
    ds_read_b64_tr_b16 v[160:161], v17 offset:9216
    ds_read_b64_tr_b16 v[162:163], v17 offset:9984
    ds_read_b64_tr_b16 v[164:165], v17 offset:9280
    ds_read_b64_tr_b16 v[166:167], v17 offset:10048
    ds_read_b64_tr_b16 v[168:169], v17 offset:9344
    ds_read_b64_tr_b16 v[170:171], v17 offset:10112
    buffer_load_dword v226, v227, s[32:35], s76 offen sc1
    ds_read_b64_tr_b16 v[172:173], v17 offset:12288
    ds_read_b64_tr_b16 v[174:175], v17 offset:13056
    ds_read_b64_tr_b16 v[176:177], v17 offset:12352
    ds_read_b64_tr_b16 v[178:179], v17 offset:13120
    ds_read_b64_tr_b16 v[180:181], v17 offset:12416
    ds_read_b64_tr_b16 v[182:183], v17 offset:13184
    ds_read_b64_tr_b16 v[184:185], v17 offset:15360
    ds_read_b64_tr_b16 v[186:187], v17 offset:16128
    ds_read_b64_tr_b16 v[188:189], v17 offset:15424
    ds_read_b64_tr_b16 v[190:191], v17 offset:16192
    ds_read_b64_tr_b16 v[192:193], v17 offset:15488
    ds_read_b64_tr_b16 v[194:195], v17 offset:16256
    ds_read_b64_tr_b16 v[196:197], v17 offset:18432
    ds_read_b64_tr_b16 v[198:199], v17 offset:19200
    ds_read_b64_tr_b16 v[200:201], v17 offset:18496
    ds_read_b64_tr_b16 v[202:203], v17 offset:19264
    ds_read_b64_tr_b16 v[204:205], v17 offset:18560
    ds_read_b64_tr_b16 v[206:207], v17 offset:19328
    ds_read_b64_tr_b16 v[208:209], v17 offset:21504
    ds_read_b64_tr_b16 v[210:211], v17 offset:22272
    ds_read_b64_tr_b16 v[212:213], v17 offset:21568
    ds_read_b64_tr_b16 v[214:215], v17 offset:22336
    ds_read_b64_tr_b16 v[216:217], v17 offset:21632
    ds_read_b64_tr_b16 v[218:219], v17 offset:22400
    v_lshlrev_b32 v224, 3, v2
    v_lshl_add_u32 v225, v7, 2, v224
    s_lshl_b32 s17, s3, 9
    v_add_u32 v224, s17, v224
    s_mov_b32 s78, 0
L_f3_44:
    s_waitcnt vmcnt(0)
    v_cmp_ne_u32 vcc, s70, v226
    s_cbranch_vccz L_f3x_45
    s_add_u32 s78, s78, 1
    s_cmp_lt_u32 s78, 60000
    s_cbranch_scc0 L_f3x_45
    buffer_load_dword v226, v227, s[32:35], s76 offen sc1
    s_branch L_f3_44
L_f3x_45:
    s_waitcnt lgkmcnt(0)
    v_mfma_f32_16x16x32_bf16 v[52:55], v[220:223], v[124:127], 0
    s_add_u32 s79, s77, 0
    buffer_load_dwordx4 a[0:3], v8, s[32:35], s79 offen offset:0 sc1
    v_mfma_f32_16x16x32_bf16 v[56:59], v[220:223], v[128:131], 0
    v_mfma_f32_16x16x32_bf16 v[60:63], v[220:223], v[132:135], 0
    buffer_load_dwordx4 a[4:7], v8, s[32:35], s79 offen offset:1024 sc1
    v_mfma_f32_16x16x32_bf16 v[52:55], v[220:223], v[136:139], v[52:55]
    v_mfma_f32_16x16x32_bf16 v[56:59], v[220:223], v[140:143], v[56:59]
    buffer_load_dwordx4 a[8:11], v8, s[32:35], s79 offen offset:2048 sc1
    v_mfma_f32_16x16x32_bf16 v[60:63], v[220:223], v[144:147], v[60:63]
    v_mfma_f32_16x16x32_bf16 v[52:55], v[220:223], v[148:151], v[52:55]
    buffer_load_dwordx4 a[12:15], v8, s[32:35], s79 offen offset:3072 sc1
    v_mfma_f32_16x16x32_bf16 v[56:59], v[220:223], v[152:155], v[56:59]
    s_add_u32 s79, s77, 4096
    v_mfma_f32_16x16x32_bf16 v[60:63], v[220:223], v[156:159], v[60:63]
    buffer_load_dwordx4 a[16:19], v8, s[32:35], s79 offen offset:0 sc1
    v_mfma_f32_16x16x32_bf16 v[52:55], v[220:223], v[160:163], v[52:55]
    v_mfma_f32_16x16x32_bf16 v[56:59], v[220:223], v[164:167], v[56:59]
    buffer_load_dwordx4 a[20:23], v8, s[32:35], s79 offen offset:1024 sc1
    v_mfma_f32_16x16x32_bf16 v[60:63], v[220:223], v[168:171], v[60:63]
    v_mfma_f32_16x16x32_bf16 v[52:55], v[220:223], v[172:175], v[52:55]
    buffer_load_dwordx4 a[24:27], v8, s[32:35], s79 offen offset:2048 sc1
    v_mfma_f32_16x16x32_bf16 v[56:59], v[220:223], v[176:179], v[56:59]
    v_mfma_f32_16x16x32_bf16 v[60:63], v[220:223], v[180:183], v[60:63]
    buffer_load_dwordx4 a[28:31], v8, s[32:35], s79 offen offset:3072 sc1
    v_mfma_f32_16x16x32_bf16 v[52:55], v[220:223], v[184:187], v[52:55]
    s_add_u32 s79, s77, 8192
    v_mfma_f32_16x16x32_bf16 v[56:59], v[220:223], v[188:191], v[56:59]
    buffer_load_dwordx4 a[32:35], v8, s[32:35], s79 offen offset:0 sc1
    v_mfma_f32_16x16x32_bf16 v[60:63], v[220:223], v[192:195], v[60:63]
    v_mfma_f32_16x16x32_bf16 v[52:55], v[220:223], v[196:199], v[52:55]
    v_mfma_f32_16x16x32_bf16 v[56:59], v[220:223], v[200:203], v[56:59]
    v_mfma_f32_16x16x32_bf16 v[60:63], v[220:223], v[204:207], v[60:63]
    v_mfma_f32_16x16x32_bf16 v[52:55], v[220:223], v[208:211], v[52:55]
    v_mfma_f32_16x16x32_bf16 v[56:59], v[220:223], v[212:215], v[56:59]
    v_mfma_f32_16x16x32_bf16 v[60:63], v[220:223], v[216:219], v[60:63]
    s_nop 5
    ds_write_b64 v224, v[52:53] offset:63488
    ds_write_b64 v224, v[56:57] offset:63616
    ds_write_b64 v224, v[60:61] offset:63744
    s_waitcnt vmcnt(8) lgkmcnt(6)
    v_mfma_f32_32x32x16_bf16 v[52:67], v[100:103], a[0:3], 0
    ds_read_b64_tr_b16 v[124:125], v18 offset:6144
    ds_read_b64_tr_b16 v[126:127], v18 offset:6912
    buffer_load_dwordx4 a[36:39], v8, s[32:35], s79 offen offset:1024 sc1
    v_mfma_f32_32x32x16_bf16 v[68:83], v[104:107], a[0:3], 0
    ds_read_b64_tr_b16 v[128:129], v18 offset:6208
    ds_read_b64_tr_b16 v[130:131], v18 offset:6976
    v_mfma_f32_32x32x16_bf16 v[84:99], v[108:111], a[0:3], 0
    ds_read_b64_tr_b16 v[132:133], v18 offset:6272
    ds_read_b64_tr_b16 v[134:135], v18 offset:7040
    s_waitcnt vmcnt(8) lgkmcnt(6)
    v_mfma_f32_32x32x16_bf16 v[52:67], v[112:115], a[4:7], v[52:67]
    ds_read_b64_tr_b16 v[100:101], v18 offset:9216
    ds_read_b64_tr_b16 v[102:103], v18 offset:9984
    buffer_load_dwordx4 a[40:43], v8, s[32:35], s79 offen offset:2048 sc1
    v_mfma_f32_32x32x16_bf16 v[68:83], v[116:119], a[4:7], v[68:83]
    ds_read_b64_tr_b16 v[104:105], v18 offset:9280
    ds_read_b64_tr_b16 v[106:107], v18 offset:10048
    buffer_load_dwordx4 a[44:47], v8, s[32:35], s79 offen offset:3072 sc1
    v_mfma_f32_32x32x16_bf16 v[84:99], v[120:123], a[4:7], v[84:99]
    ds_read_b64_tr_b16 v[108:109], v18 offset:9344
    ds_read_b64_tr_b16 v[110:111], v18 offset:10112
    s_waitcnt vmcnt(9) lgkmcnt(6)
    v_mfma_f32_32x32x16_bf16 v[52:67], v[124:127], a[8:11], v[52:67]
    ds_read_b64_tr_b16 v[112:113], v18 offset:12288
    ds_read_b64_tr_b16 v[114:115], v18 offset:13056
    s_add_u32 s79, s77, 12288
    buffer_load_dwordx4 a[48:51], v8, s[32:35], s79 offen offset:0 sc1
    v_mfma_f32_32x32x16_bf16 v[68:83], v[128:131], a[8:11], v[68:83]
    ds_read_b64_tr_b16 v[116:117], v18 offset:12352
    ds_read_b64_tr_b16 v[118:119], v18 offset:13120
    v_mfma_f32_32x32x16_bf16 v[84:99], v[132:135], a[8:11], v[84:99]
    ds_read_b64_tr_b16 v[120:121], v18 offset:12416
    ds_read_b64_tr_b16 v[122:123], v18 offset:13184
    s_waitcnt vmcnt(9) lgkmcnt(6)
    v_mfma_f32_32x32x16_bf16 v[52:67], v[100:103], a[12:15], v[52:67]
    ds_read_b64_tr_b16 v[124:125], v18 offset:15360
    ds_read_b64_tr_b16 v[126:127], v18 offset:16128
    buffer_load_dwordx4 a[52:55], v8, s[32:35], s79 offen offset:1024 sc1
    v_mfma_f32_32x32x16_bf16 v[68:83], v[104:107], a[12:15], v[68:83]
    ds_read_b64_tr_b16 v[128:129], v18 offset:15424
    ds_read_b64_tr_b16 v[130:131], v18 offset:16192
    buffer_load_dwordx4 a[56:59], v8, s[32:35], s79 offen offset:2048 sc1
    v_mfma_f32_32x32x16_bf16 v[84:99], v[108:111], a[12:15], v[84:99]
    ds_read_b64_tr_b16 v[132:133], v18 offset:15488
    ds_read_b64_tr_b16 v[134:135], v18 offset:16256
    s_waitcnt vmcnt(10) lgkmcnt(6)
    v_mfma_f32_32x32x16_bf16 v[52:67], v[112:115], a[16:19], v[52:67]
    ds_read_b64_tr_b16 v[100:101], v18 offset:18432
    ds_read_b64_tr_b16 v[102:103], v18 offset:19200
    buffer_load_dwordx4 a[60:63], v8, s[32:35], s79 offen offset:3072 sc1
    v_mfma_f32_32x32x16_bf16 v[68:83], v[116:119], a[16:19], v[68:83]
    ds_read_b64_tr_b16 v[104:105], v18 offset:18496
    ds_read_b64_tr_b16 v[106:107], v18 offset:19264
    v_mfma_f32_32x32x16_bf16 v[84:99], v[120:123], a[16:19], v[84:99]
    ds_read_b64_tr_b16 v[108:109], v18 offset:18560
    ds_read_b64_tr_b16 v[110:111], v18 offset:19328
    s_waitcnt vmcnt(10) lgkmcnt(6)
    v_mfma_f32_32x32x16_bf16 v[52:67], v[124:127], a[20:23], v[52:67]
    ds_read_b64_tr_b16 v[112:113], v18 offset:21504
    ds_read_b64_tr_b16 v[114:115], v18 offset:22272
    s_add_u32 s79, s18, 0
    buffer_load_dwordx4 a[64:67], v8, s[32:35], s79 offen offset:0 sc1
    v_mfma_f32_32x32x16_bf16 v[68:83], v[128:131], a[20:23], v[68:83]
    ds_read_b64_tr_b16 v[116:117], v18 offset:21568
    ds_read_b64_tr_b16 v[118:119], v18 offset:22336
    buffer_load_dwordx4 a[68:71], v8, s[32:35], s79 offen offset:1024 sc1
    v_mfma_f32_32x32x16_bf16 v[84:99], v[132:135], a[20:23], v[84:99]
    ds_read_b64_tr_b16 v[120:121], v18 offset:21632
    ds_read_b64_tr_b16 v[122:123], v18 offset:22400
    s_waitcnt vmcnt(11) lgkmcnt(6)
    v_mfma_f32_32x32x16_bf16 v[52:67], v[100:103], a[24:27], v[52:67]
    ds_read_b64_tr_b16 v[124:125], v18 offset:24576
    ds_read_b64_tr_b16 v[126:127], v18 offset:25344
    buffer_load_dwordx4 a[72:75], v8, s[32:35], s79 offen offset:2048 sc1
    v_mfma_f32_32x32x16_bf16 v[68:83], v[104:107], a[24:27], v[68:83]
    ds_read_b64_tr_b16 v[128:129], v18 offset:24640
    ds_read_b64_tr_b16 v[130:131], v18 offset:25408
    v_mfma_f32_32x32x16_bf16 v[84:99], v[108:111], a[24:27], v[84:99]
    ds_read_b64_tr_b16 v[132:133], v18 offset:24704
    ds_read_b64_tr_b16 v[134:135], v18 offset:25472
    s_waitcnt vmcnt(11) lgkmcnt(6)
    v_mfma_f32_32x32x16_bf16 v[52:67], v[112:115], a[28:31], v[52:67]
    ds_read_b64_tr_b16 v[100:101], v18 offset:27648
    ds_read_b64_tr_b16 v[102:103], v18 offset:28416
    buffer_load_dwordx4 a[76:79], v8, s[32:35], s79 offen offset:3072 sc1
    v_mfma_f32_32x32x16_bf16 v[68:83], v[116:119], a[28:31], v[68:83]
    ds_read_b64_tr_b16 v[104:105], v18 offset:27712
    ds_read_b64_tr_b16 v[106:107], v18 offset:28480
    s_add_u32 s79, s18, 4096
    buffer_load_dwordx4 a[80:83], v8, s[32:35], s79 offen offset:0 sc1
    v_mfma_f32_32x32x16_bf16 v[84:99], v[120:123], a[28:31], v[84:99]
    ds_read_b64_tr_b16 v[108:109], v18 offset:27776
    ds_read_b64_tr_b16 v[110:111], v18 offset:28544
    s_waitcnt vmcnt(12) lgkmcnt(6)
    v_mfma_f32_32x32x16_bf16 v[52:67], v[124:127], a[32:35], v[52:67]
    ds_read_b64_tr_b16 v[112:113], v18 offset:30720
    ds_read_b64_tr_b16 v[114:115], v18 offset:31488
    buffer_load_dwordx4 a[84:87], v8, s[32:35], s79 offen offset:1024 sc1
    v_mfma_f32_32x32x16_bf16 v[68:83], v[128:131], a[32:35], v[68:83]
    ds_read_b64_tr_b16 v[116:117], v18 offset:30784
    ds_read_b64_tr_b16 v[118:119], v18 offset:31552
    v_mfma_f32_32x32x16_bf16 v[84:99], v[132:135], a[32:35], v[84:99]
    ds_read_b64_tr_b16 v[120:121], v18 offset:30848
    ds_read_b64_tr_b16 v[122:123], v18 offset:31616
    s_waitcnt vmcnt(12) lgkmcnt(6)
    s_barrier
    v_mfma_f32_32x32x16_bf16 v[52:67], v[100:103], a[36:39], v[52:67]
    ds_read_b32 v180, v225 offset:63488
    ds_read_b32 v181, v225 offset:64000
    ds_read_b32 v182, v225 offset:64512
    ds_read_b32 v183, v225 offset:65024
    ds_read_b64_tr_b16 v[124:125], v18 offset:33792
    ds_read_b64_tr_b16 v[126:127], v18 offset:34560
    buffer_load_dwordx4 a[88:91], v8, s[32:35], s79 offen offset:2048 sc1
    v_mfma_f32_32x32x16_bf16 v[68:83], v[104:107], a[36:39], v[68:83]
    ds_read_b32 v184, v225 offset:63616
    ds_read_b32 v185, v225 offset:64128
    ds_read_b32 v186, v225 offset:64640
    ds_read_b32 v187, v225 offset:65152
    ds_read_b64_tr_b16 v[128:129], v18 offset:33856
    ds_read_b64_tr_b16 v[130:131], v18 offset:34624
    buffer_load_dwordx4 a[92:95], v8, s[32:35], s79 offen offset:3072 sc1
    v_mfma_f32_32x32x16_bf16 v[84:99], v[108:111], a[36:39], v[84:99]
    ds_read_b32 v188, v225 offset:63744
    ds_read_b32 v189, v225 offset:64256
    ds_read_b32 v190, v225 offset:64768
    ds_read_b32 v191, v225 offset:65280
    ds_read_b64_tr_b16 v[132:133], v18 offset:33920
    ds_read_b64_tr_b16 v[134:135], v18 offset:34688
    s_waitcnt vmcnt(13) lgkmcnt(6)
    v_mfma_f32_32x32x16_bf16 v[52:67], v[112:115], a[40:43], v[52:67]
    ds_read_b64_tr_b16 v[100:101], v18 offset:36864
    ds_read_b64_tr_b16 v[102:103], v18 offset:37632
    s_add_u32 s79, s18, 8192
    buffer_load_dwordx4 a[96:99], v8, s[32:35], s79 offen offset:0 sc1
    v_mfma_f32_32x32x16_bf16 v[68:83], v[116:119], a[40:43], v[68:83]
    ds_read_b64_tr_b16 v[104:105], v18 offset:36928
    ds_read_b64_tr_b16 v[106:107], v18 offset:37696
    v_mfma_f32_32x32x16_bf16 v[84:99], v[120:123], a[40:43], v[84:99]
    ds_read_b64_tr_b16 v[108:109], v18 offset:36992
    ds_read_b64_tr_b16 v[110:111], v18 offset:37760
    s_waitcnt vmcnt(13) lgkmcnt(6)
    v_mfma_f32_32x32x16_bf16 v[52:67], v[124:127], a[44:47], v[52:67]
    ds_read_b64_tr_b16 v[112:113], v18 offset:39936
    ds_read_b64_tr_b16 v[114:115], v18 offset:40704
    buffer_load_dwordx4 a[100:103], v8, s[32:35], s79 offen offset:1024 sc1
    v_mfma_f32_32x32x16_bf16 v[68:83], v[128:131], a[44:47], v[68:83]
    ds_read_b64_tr_b16 v[116:117], v18 offset:40000
    ds_read_b64_tr_b16 v[118:119], v18 offset:40768
    buffer_load_dwordx4 a[104:107], v8, s[32:35], s79 offen offset:2048 sc1
    v_mfma_f32_32x32x16_bf16 v[84:99], v[132:135], a[44:47], v[84:99]
    ds_read_b64_tr_b16 v[120:121], v18 offset:40064
    ds_read_b64_tr_b16 v[122:123], v18 offset:40832
    s_waitcnt vmcnt(14) lgkmcnt(6)
    v_mfma_f32_32x32x16_bf16 v[52:67], v[100:103], a[48:51], v[52:67]
    ds_read_b64_tr_b16 v[124:125], v18 offset:43008
    ds_read_b64_tr_b16 v[126:127], v18 offset:43776
    buffer_load_dwordx4 a[108:111], v8, s[32:35], s79 offen offset:3072 sc1
    v_mov_b32 v231, 0
    v_mov_b32 v235, 0
    v_mov_b32 v239, 0
    v_mfma_f32_32x32x16_bf16 v[68:83], v[104:107], a[48:51], v[68:83]
    ds_read_b64_tr_b16 v[128:129], v18 offset:43072
    ds_read_b64_tr_b16 v[130:131], v18 offset:43840
    v_add_f32 v180, v180, v182
    v_add_f32 v181, v181, v183
    v_add_f32 v180, v180, v181
    v_cvt_pk_bf16_f32 v181, v180, v180
    v_and_b32 v182, 0xffff0000, v181
    v_mfma_f32_32x32x16_bf16 v[84:99], v[108:111], a[48:51], v[84:99]
    ds_read_b64_tr_b16 v[132:133], v18 offset:43136
    ds_read_b64_tr_b16 v[134:135], v18 offset:43904
    v_sub_f32 v182, v180, v182
    v_cvt_pk_bf16_f32 v228, v180, v182
    v_and_b32 v181, 0xffff, v181
    v_lshl_or_b32 v229, v25, 16, v181
    v_mov_b32 v230, v25
    s_waitcnt vmcnt(14) lgkmcnt(6)
    v_mfma_f32_32x32x16_bf16 v[52:67], v[112:115], a[52:55], v[52:67]
    ds_read_b64_tr_b16 v[100:101], v18 offset:46080
    ds_read_b64_tr_b16 v[102:103], v18 offset:46848
    s_add_u32 s79, s18, 12288
    buffer_load_dwordx4 a[112:115], v8, s[32:35], s79 offen offset:0 sc1
    v_add_f32 v184, v184, v186
    v_add_f32 v185, v185, v187
    v_mfma_f32_32x32x16_bf16 v[68:83], v[116:119], a[52:55], v[68:83]
    ds_read_b64_tr_b16 v[104:105], v18 offset:46144
    ds_read_b64_tr_b16 v[106:107], v18 offset:46912
    buffer_load_dwordx4 a[116:119], v8, s[32:35], s79 offen offset:1024 sc1
    v_add_f32 v184, v184, v185
    v_cvt_pk_bf16_f32 v185, v184, v184
    v_and_b32 v186, 0xffff0000, v185
    v_sub_f32 v186, v184, v186
    v_mfma_f32_32x32x16_bf16 v[84:99], v[120:123], a[52:55], v[84:99]
    ds_read_b64_tr_b16 v[108:109], v18 offset:46208
    ds_read_b64_tr_b16 v[110:111], v18 offset:46976
    v_cvt_pk_bf16_f32 v232, v184, v186
    v_and_b32 v185, 0xffff, v185
    v_lshl_or_b32 v233, v26, 16, v185
    v_mov_b32 v234, v26
    v_add_f32 v188, v188, v190
    s_waitcnt vmcnt(15) lgkmcnt(6)
    v_mfma_f32_32x32x16_bf16 v[52:67], v[124:127], a[56:59], v[52:67]
    ds_read_b64_tr_b16 v[112:113], v19 offset:0
    ds_read_b64_tr_b16 v[114:115], v19 offset:768
    buffer_load_dwordx4 a[120:123], v8, s[32:35], s79 offen offset:2048 sc1
    v_add_f32 v189, v189, v191
    v_add_f32 v188, v188, v189
    v_cvt_pk_bf16_f32 v189, v188, v188
    v_mfma_f32_32x32x16_bf16 v[68:83], v[128:131], a[56:59], v[68:83]
    ds_read_b64_tr_b16 v[116:117], v19 offset:64
    ds_read_b64_tr_b16 v[118:119], v19 offset:832
    v_and_b32 v190, 0xffff0000, v189
    v_sub_f32 v190, v188, v190
    v_cvt_pk_bf16_f32 v236, v188, v190
    v_and_b32 v189, 0xffff, v189
    v_lshl_or_b32 v237, v27, 16, v189
    v_mfma_f32_32x32x16_bf16 v[84:99], v[132:135], a[56:59], v[84:99]
    ds_read_b64_tr_b16 v[120:121], v19 offset:128
    ds_read_b64_tr_b16 v[122:123], v19 offset:896
    v_mov_b32 v238, v27
    v_cndmask_b32 v228, 0, v228, s[84:85]
    v_cndmask_b32 v229, 0, v229, s[84:85]
    v_cndmask_b32 v230, 0, v230, s[84:85]
    v_cndmask_b32 v232, 0, v232, s[84:85]
    s_waitcnt vmcnt(15) lgkmcnt(6)
    v_mfma_f32_32x32x16_bf16 v[52:67], v[100:103], a[60:63], v[52:67]
    ds_read_b64_tr_b16 v[124:125], v19 offset:3072
    ds_read_b64_tr_b16 v[126:127], v19 offset:3840
    buffer_load_dwordx4 a[124:127], v8, s[32:35], s79 offen offset:3072 sc1
    v_cndmask_b32 v233, 0, v233, s[84:85]
    v_cndmask_b32 v234, 0, v234, s[84:85]
    v_cndmask_b32 v236, 0, v236, s[84:85]
    v_mfma_f32_32x32x16_bf16 v[68:83], v[104:107], a[60:63], v[68:83]
    ds_read_b64_tr_b16 v[128:129], v19 offset:3136
    ds_read_b64_tr_b16 v[130:131], v19 offset:3904
    buffer_load_dwordx4 v[196:199], v8, s[32:35], s73 offen offset:0 sc1
    v_cndmask_b32 v237, 0, v237, s[84:85]
    v_cndmask_b32 v238, 0, v238, s[84:85]
    v_mfma_f32_32x32x16_bf16 v[84:99], v[108:111], a[60:63], v[84:99]
    ds_read_b64_tr_b16 v[132:133], v19 offset:3200
    ds_read_b64_tr_b16 v[134:135], v19 offset:3968
    s_waitcnt vmcnt(16) lgkmcnt(6)
    v_mfma_f32_32x32x16_bf16 v[52:67], v[112:115], a[64:67], v[52:67]
    ds_read_b64_tr_b16 v[100:101], v19 offset:6144
    ds_read_b64_tr_b16 v[102:103], v19 offset:6912
    buffer_load_dwordx4 v[200:203], v8, s[32:35], s73 offen offset:1024 sc1
    v_mfma_f32_32x32x16_bf16 v[68:83], v[116:119], a[64:67], v[68:83]
    ds_read_b64_tr_b16 v[104:105], v19 offset:6208
    ds_read_b64_tr_b16 v[106:107], v19 offset:6976
    s_lshl_b32 s77, s66, 1
    s_add_u32 s77, s77, s93
    s_lshl_b32 s77, s77, 3
    s_add_u32 s77, s77, s67
    s_lshl_b32 s77, s77, 1
    s_add_u32 s77, s77, s92
    s_and_b32 s75, s77, 15
    s_lshr_b32 s77, s77, 4
    s_mul_i32 s77, s77, 88064
    s_mul_i32 s75, s75, 3456
    s_add_u32 s77, s77, s75
    s_add_u32 s77, s77, 10518528
    v_min_u32 v216, 26, v1
    v_lshlrev_b32 v216, 7, v216
    buffer_load_dword v217, v216, s[32:35], s77 offen sc1
    v_mfma_f32_32x32x16_bf16 v[84:99], v[120:123], a[64:67], v[84:99]
    ds_read_b64_tr_b16 v[108:109], v19 offset:6272
    ds_read_b64_tr_b16 v[110:111], v19 offset:7040
    s_waitcnt vmcnt(17) lgkmcnt(6)
    s_barrier
    v_mfma_f32_32x32x16_bf16 v[52:67], v[124:127], a[68:71], v[52:67]
    ds_read_b64_tr_b16 v[112:113], v19 offset:9216
    ds_read_b64_tr_b16 v[114:115], v19 offset:9984
    s_add_u32 m0, s20, 8192
    s_nop 0
    buffer_load_dwordx4 v20, s[44:47], s26 offen offset:0 lds
    v_mfma_f32_32x32x16_bf16 v[68:83], v[128:131], a[68:71], v[68:83]
    ds_read_b64_tr_b16 v[116:117], v19 offset:9280
    ds_read_b64_tr_b16 v[118:119], v19 offset:10048
    v_mfma_f32_32x32x16_bf16 v[84:99], v[132:135], a[68:71], v[84:99]
    ds_read_b64_tr_b16 v[120:121], v19 offset:9344
    ds_read_b64_tr_b16 v[122:123], v19 offset:10112
    s_waitcnt vmcnt(17) lgkmcnt(6)
    v_mfma_f32_32x32x16_bf16 v[52:67], v[100:103], a[72:75], v[52:67]
    ds_read_b64_tr_b16 v[124:125], v19 offset:12288
    ds_read_b64_tr_b16 v[126:127], v19 offset:13056
    buffer_load_dwordx4 v21, s[44:47], s26 offen offset:1024 lds
    v_mfma_f32_32x32x16_bf16 v[68:83], v[104:107], a[72:75], v[68:83]
    ds_read_b64_tr_b16 v[128:129], v19 offset:15360
    ds_read_b64_tr_b16 v[130:131], v19 offset:16128
    v_mfma_f32_32x32x16_bf16 v[84:99], v[108:111], a[72:75], v[84:99]
    ds_read_b64_tr_b16 v[132:133], v19 offset:18432
    ds_read_b64_tr_b16 v[134:135], v19 offset:19200
    s_waitcnt vmcnt(17) lgkmcnt(6)
    v_mfma_f32_32x32x16_bf16 v[52:67], v[112:115], a[76:79], v[52:67]
    ds_read_b64_tr_b16 v[100:101], v19 offset:21504
    ds_read_b64_tr_b16 v[102:103], v19 offset:22272
    buffer_load_dwordx4 v22, s[44:47], s26 offen offset:2048 lds
    v_mfma_f32_32x32x16_bf16 v[68:83], v[116:119], a[76:79], v[68:83]
    ds_read_b64_tr_b16 v[104:105], v19 offset:24576
    ds_read_b64_tr_b16 v[106:107], v19 offset:25344
    v_mfma_f32_32x32x16_bf16 v[84:99], v[120:123], a[76:79], v[84:99]
    ds_read_b64_tr_b16 v[108:109], v19 offset:27648
    ds_read_b64_tr_b16 v[110:111], v19 offset:28416
    s_waitcnt vmcnt(17) lgkmcnt(6)
    v_mfma_f32_32x32x16_bf16 v[52:67], v[124:127], a[80:83], v[52:67]
    ds_read_b64_tr_b16 v[112:113], v19 offset:30720
    ds_read_b64_tr_b16 v[114:115], v19 offset:31488
    buffer_load_dwordx4 v23, s[44:47], s26 offen offset:3072 lds
    s_waitcnt vmcnt(17)
    v_mfma_f32_32x32x16_bf16 v[52:67], v[128:131], a[84:87], v[52:67]
    ds_read_b64_tr_b16 v[116:117], v19 offset:33792
    ds_read_b64_tr_b16 v[118:119], v19 offset:34560
    s_waitcnt vmcnt(5)
    v_mfma_f32_32x32x16_bf16 v[52:67], v[132:135], a[88:91], v[52:67]
    ds_read_b64_tr_b16 v[120:121], v19 offset:36864
    ds_read_b64_tr_b16 v[122:123], v19 offset:37632
    v_add_f32 v196, v196, v200
    v_add_f32 v197, v197, v201
    v_add_f32 v198, v198, v202
    v_add_f32 v199, v199, v203
    s_waitcnt vmcnt(15) lgkmcnt(6)
    v_mfma_f32_32x32x16_bf16 v[52:67], v[100:103], a[92:95], v[52:67]
    ds_read_b64_tr_b16 v[124:125], v19 offset:39936
    ds_read_b64_tr_b16 v[126:127], v19 offset:40704
    s_add_u32 m0, s21, 0
    s_nop 0
    buffer_load_dwordx4 v20, s[44:47], s28 offen offset:0 lds
    v_add_f32 v196, v196, v198
    v_add_f32 v197, v197, v199
    s_waitcnt vmcnt(15)
    v_mfma_f32_32x32x16_bf16 v[52:67], v[104:107], a[96:99], v[52:67]
    ds_read_b64_tr_b16 v[128:129], v19 offset:43008
    ds_read_b64_tr_b16 v[130:131], v19 offset:43776
    v_add_f32 v196, v196, v197
    v_mov_b32 v197, v196
    s_nop 1
    v_permlane32_swap_b32 v196, v197
    s_waitcnt vmcnt(14)
    v_mfma_f32_32x32x16_bf16 v[52:67], v[108:111], a[100:103], v[52:67]
    ds_read_b64_tr_b16 v[132:133], v19 offset:46080
    ds_read_b64_tr_b16 v[134:135], v19 offset:46848
    v_mul_f32 v196, s94, v196
    v_mul_f32 v198, v196, v196
    v_fma_f32 v197, v197, s94, -v198
    v_max_f32 v197, 0, v197
    s_waitcnt vmcnt(13) lgkmcnt(6)
    v_mfma_f32_32x32x16_bf16 v[52:67], v[112:115], a[104:107], v[52:67]
    ds_read_b64_tr_b16 v[100:101], v19 offset:12352
    ds_read_b64_tr_b16 v[102:103], v19 offset:13120
    buffer_load_dwordx4 v21, s[44:47], s28 offen offset:1024 lds
    v_add_f32 v197, 0x3727c5ac, v197
    v_rsq_f32 v198, v197
    s_waitcnt vmcnt(13)
    v_mfma_f32_32x32x16_bf16 v[52:67], v[116:119], a[108:111], v[52:67]
    ds_read_b64_tr_b16 v[104:105], v19 offset:15424
    ds_read_b64_tr_b16 v[106:107], v19 offset:16192
    v_sub_f32 v196, 0, v196
    v_mul_f32 v197, v197, v198
    v_cvt_pk_bf16_f32 v212, v196, v196
    v_cvt_pk_bf16_f32 v200, v197, v197
    s_waitcnt vmcnt(12)
    v_mfma_f32_32x32x16_bf16 v[52:67], v[120:123], a[112:115], v[52:67]
    ds_read_b64_tr_b16 v[108:109], v19 offset:18496
    ds_read_b64_tr_b16 v[110:111], v19 offset:19264
    v_and_b32 v201, 0xffff0000, v212
    v_and_b32 v200, 0xffff0000, v200
    v_sub_f32 v201, v196, v201
    v_sub_f32 v200, v197, v200
    s_waitcnt vmcnt(11) lgkmcnt(6)
    v_mfma_f32_32x32x16_bf16 v[52:67], v[124:127], a[116:119], v[52:67]
    ds_read_b64_tr_b16 v[112:113], v19 offset:21568
    ds_read_b64_tr_b16 v[114:115], v19 offset:22336
    buffer_load_dwordx4 v22, s[44:47], s28 offen offset:2048 lds
    v_cvt_pk_bf16_f32 v213, v201, v197
    v_cvt_pk_bf16_f32 v214, v200, 0
    v_mov_b32 v215, 0
    s_waitcnt vmcnt(11)
    v_mfma_f32_32x32x16_bf16 v[52:67], v[128:131], a[120:123], v[52:67]
    ds_read_b64_tr_b16 v[116:117], v19 offset:24640
    ds_read_b64_tr_b16 v[118:119], v19 offset:25408
    v_mul_f32 v205, 0xc0135761, v198
    v_mul_f32 v204, v198, v198
    v_mul_f32 v204, v204, v205
    v_mul_f32 v204, 0x3d372713, v204
    s_waitcnt vmcnt(10)
    v_mfma_f32_32x32x16_bf16 v[52:67], v[132:135], a[124:127], v[52:67]
    ds_read_b64_tr_b16 v[120:121], v19 offset:27712
    ds_read_b64_tr_b16 v[122:123], v19 offset:28480
    v_mov_b32 v206, v197
    v_mfma_f32_32x32x16_bf16 v[52:67], v[228:231], v[212:215], v[52:67]
    s_waitcnt lgkmcnt(6)
    v_mfma_f32_32x32x16_bf16 v[68:83], v[100:103], a[80:83], v[68:83]
    ds_read_b64_tr_b16 v[124:125], v19 offset:30784
    ds_read_b64_tr_b16 v[126:127], v19 offset:31552
    buffer_load_dwordx4 v23, s[44:47], s28 offen offset:3072 lds
    v_mfma_f32_32x32x16_bf16 v[68:83], v[104:107], a[84:87], v[68:83]
    ds_read_b64_tr_b16 v[128:129], v19 offset:33856
    ds_read_b64_tr_b16 v[130:131], v19 offset:34624
    v_mfma_f32_32x32x16_bf16 v[68:83], v[108:111], a[88:91], v[68:83]
    ds_read_b64_tr_b16 v[132:133], v19 offset:36928
    ds_read_b64_tr_b16 v[134:135], v19 offset:37696
    s_nop 0
    v_mul_f32 v152, v52, v52
    v_mul_f32 v153, v53, v53
    v_mul_f32 v154, v54, v54
    v_mul_f32 v155, v55, v55
    v_fma_f32 v152, v152, v204, v205
    s_waitcnt lgkmcnt(6)
    v_mfma_f32_32x32x16_bf16 v[68:83], v[112:115], a[92:95], v[68:83]
    ds_read_b64_tr_b16 v[100:101], v19 offset:40000
    ds_read_b64_tr_b16 v[102:103], v19 offset:40768
    s_add_u32 m0, s21, 4096
    s_nop 0
    buffer_load_dwordx4 v20, s[44:47], s29 offen offset:0 lds
    v_fma_f32 v153, v153, v204, v205
    v_fma_f32 v154, v154, v204, v205
    v_mfma_f32_32x32x16_bf16 v[68:83], v[116:119], a[96:99], v[68:83]
    ds_read_b64_tr_b16 v[104:105], v19 offset:43072
    ds_read_b64_tr_b16 v[106:107], v19 offset:43840
    v_fma_f32 v155, v155, v204, v205
    v_mul_f32 v152, v152, v52
    v_mul_f32 v153, v153, v53
    v_mul_f32 v154, v154, v54
    v_mul_f32 v155, v155, v55
    v_mfma_f32_32x32x16_bf16 v[68:83], v[120:123], a[100:103], v[68:83]
    ds_read_b64_tr_b16 v[108:109], v19 offset:46144
    ds_read_b64_tr_b16 v[110:111], v19 offset:46912
    v_exp_f32 v152, v152
    v_exp_f32 v153, v153
    v_exp_f32 v154, v154
    s_waitcnt lgkmcnt(6)
    v_mfma_f32_32x32x16_bf16 v[68:83], v[124:127], a[104:107], v[68:83]
    ds_read_b64_tr_b16 v[112:113], v19 offset:12416
    ds_read_b64_tr_b16 v[114:115], v19 offset:13184
    buffer_load_dwordx4 v21, s[44:47], s29 offen offset:1024 lds
    v_exp_f32 v155, v155
    v_fma_f32 v152, v152, v206, v206
    v_mfma_f32_32x32x16_bf16 v[68:83], v[128:131], a[108:111], v[68:83]
    ds_read_b64_tr_b16 v[116:117], v19 offset:15488
    ds_read_b64_tr_b16 v[118:119], v19 offset:16256
    v_fma_f32 v153, v153, v206, v206
    v_fma_f32 v154, v154, v206, v206
    v_fma_f32 v155, v155, v206, v206
    v_rcp_f32 v152, v152
    v_mfma_f32_32x32x16_bf16 v[68:83], v[132:135], a[112:115], v[68:83]
    ds_read_b64_tr_b16 v[120:121], v19 offset:18560
    ds_read_b64_tr_b16 v[122:123], v19 offset:19328
    v_rcp_f32 v153, v153
    v_rcp_f32 v154, v154
    v_rcp_f32 v155, v155
    s_waitcnt lgkmcnt(6)
    v_mfma_f32_32x32x16_bf16 v[68:83], v[100:103], a[116:119], v[68:83]
    ds_read_b64_tr_b16 v[124:125], v19 offset:21632
    ds_read_b64_tr_b16 v[126:127], v19 offset:22400
    s_add_u32 m0, s21, 24576
    s_nop 0
    buffer_load_dwordx4 v20, s[44:47], s30 offen offset:0 lds
    v_mul_f32 v152, v152, v52
    v_mul_f32 v153, v153, v53
    v_mfma_f32_32x32x16_bf16 v[68:83], v[104:107], a[120:123], v[68:83]
    ds_read_b64_tr_b16 v[128:129], v19 offset:24704
    ds_read_b64_tr_b16 v[130:131], v19 offset:25472
    v_mul_f32 v154, v154, v54
    v_mul_f32 v155, v155, v55
    v_cvt_pk_bf16_f32 v168, v152, v153
    v_cvt_pk_bf16_f32 v169, v154, v155
    v_mfma_f32_32x32x16_bf16 v[68:83], v[108:111], a[124:127], v[68:83]
    ds_read_b64_tr_b16 v[132:133], v19 offset:27776
    ds_read_b64_tr_b16 v[134:135], v19 offset:28544
    v_mul_f32 v156, v56, v56
    v_mul_f32 v157, v57, v57
    v_mul_f32 v158, v58, v58
    v_mul_f32 v159, v59, v59
    v_fma_f32 v156, v156, v204, v205
    v_mfma_f32_32x32x16_bf16 v[68:83], v[232:235], v[212:215], v[68:83]
    s_waitcnt lgkmcnt(6)
    v_mfma_f32_32x32x16_bf16 v[84:99], v[112:115], a[80:83], v[84:99]
    ds_read_b64_tr_b16 v[100:101], v19 offset:30848
    ds_read_b64_tr_b16 v[102:103], v19 offset:31616
    buffer_load_dwordx4 v21, s[44:47], s30 offen offset:1024 lds
    v_fma_f32 v157, v157, v204, v205
    v_fma_f32 v158, v158, v204, v205
    v_fma_f32 v159, v159, v204, v205
    v_mfma_f32_32x32x16_bf16 v[84:99], v[116:119], a[84:87], v[84:99]
    ds_read_b64_tr_b16 v[104:105], v19 offset:33920
    ds_read_b64_tr_b16 v[106:107], v19 offset:34688
    v_mul_f32 v156, v156, v56
    v_mul_f32 v157, v157, v57
    v_mul_f32 v158, v158, v58
    v_mul_f32 v159, v159, v59
    v_exp_f32 v156, v156
    v_mfma_f32_32x32x16_bf16 v[84:99], v[120:123], a[88:91], v[84:99]
    ds_read_b64_tr_b16 v[108:109], v19 offset:36992
    ds_read_b64_tr_b16 v[110:111], v19 offset:37760
    v_exp_f32 v157, v157
    v_exp_f32 v158, v158
    v_exp_f32 v159, v159
    s_waitcnt lgkmcnt(6)
    v_mfma_f32_32x32x16_bf16 v[84:99], v[124:127], a[92:95], v[84:99]
    ds_read_b64_tr_b16 v[112:113], v19 offset:40064
    ds_read_b64_tr_b16 v[114:115], v19 offset:40832
    buffer_load_dwordx4 v22, s[44:47], s30 offen offset:2048 lds
    v_fma_f32 v156, v156, v206, v206
    v_fma_f32 v157, v157, v206, v206
    v_fma_f32 v158, v158, v206, v206
    v_mfma_f32_32x32x16_bf16 v[84:99], v[128:131], a[96:99], v[84:99]
    ds_read_b64_tr_b16 v[116:117], v19 offset:43136
    ds_read_b64_tr_b16 v[118:119], v19 offset:43904
    v_fma_f32 v159, v159, v206, v206
    v_rcp_f32 v156, v156
    v_rcp_f32 v157, v157
    v_mfma_f32_32x32x16_bf16 v[84:99], v[132:135], a[100:103], v[84:99]
    ds_read_b64_tr_b16 v[120:121], v19 offset:46208
    ds_read_b64_tr_b16 v[122:123], v19 offset:46976
    v_rcp_f32 v158, v158
    v_rcp_f32 v159, v159
    v_mul_f32 v156, v156, v56
    s_waitcnt lgkmcnt(6)
    s_barrier
    v_mfma_f32_32x32x16_bf16 v[84:99], v[100:103], a[104:107], v[84:99]
    buffer_load_dwordx4 v23, s[44:47], s30 offen offset:3072 lds
    v_mul_f32 v157, v157, v57
    v_mul_f32 v158, v158, v58
    v_mul_f32 v159, v159, v59
    v_cvt_pk_bf16_f32 v170, v156, v157
    v_cvt_pk_bf16_f32 v171, v158, v159
    v_mfma_f32_32x32x16_bf16 v[84:99], v[104:107], a[108:111], v[84:99]
    v_mul_f32 v160, v60, v60
    v_mul_f32 v161, v61, v61
    v_mul_f32 v162, v62, v62
    v_mul_f32 v163, v63, v63
    v_fma_f32 v160, v160, v204, v205
    v_fma_f32 v161, v161, v204, v205
    v_fma_f32 v162, v162, v204, v205
    v_mfma_f32_32x32x16_bf16 v[84:99], v[108:111], a[112:115], v[84:99]
    v_fma_f32 v163, v163, v204, v205
    v_mul_f32 v160, v160, v60
    v_mul_f32 v161, v161, v61
    v_mul_f32 v162, v162, v62
    v_mul_f32 v163, v163, v63
    v_exp_f32 v160, v160
    s_waitcnt lgkmcnt(0)
    v_mfma_f32_32x32x16_bf16 v[84:99], v[112:115], a[116:119], v[84:99]
    s_add_u32 m0, s21, 28672
    s_nop 0
    buffer_load_dwordx4 v20, s[44:47], s31 offen offset:0 lds
    v_exp_f32 v161, v161
    v_exp_f32 v162, v162
    v_mfma_f32_32x32x16_bf16 v[84:99], v[116:119], a[120:123], v[84:99]
    v_exp_f32 v163, v163
    v_fma_f32 v160, v160, v206, v206
    v_fma_f32 v161, v161, v206, v206
    v_fma_f32 v162, v162, v206, v206
    v_fma_f32 v163, v163, v206, v206
    v_rcp_f32 v160, v160
    v_mfma_f32_32x32x16_bf16 v[84:99], v[120:123], a[124:127], v[84:99]
    v_rcp_f32 v161, v161
    v_rcp_f32 v162, v162
    v_rcp_f32 v163, v163
    v_mul_f32 v160, v160, v60
    v_mfma_f32_32x32x16_bf16 v[84:99], v[236:239], v[212:215], v[84:99]
    s_barrier
    v_mul_f32 v161, v161, v61
    v_mul_f32 v162, v162, v62
    v_mul_f32 v163, v163, v63
    v_cvt_pk_bf16_f32 v172, v160, v161
    v_cvt_pk_bf16_f32 v173, v162, v163
    s_mul_i32 s73, s90, 86
    s_mul_i32 s75, s91, 6
    s_add_u32 s73, s73, s75
    s_lshl_b32 s73, s73, 10
    s_add_u32 s75, s73, 10485760
    v_pk_mul_f32 v[164:165], v[64:65], v[64:65]
    buffer_load_dwordx4 v21, s[44:47], s31 offen offset:1024 lds
    v_pk_mul_f32 v[166:167], v[66:67], v[66:67]
    v_pk_fma_f32 v[164:165], v[164:165], v[204:205], v[204:205] op_sel:[0,0,1] op_sel_hi:[1,0,1]
    v_pk_fma_f32 v[166:167], v[166:167], v[204:205], v[204:205] op_sel:[0,0,1] op_sel_hi:[1,0,1]
    v_pk_mul_f32 v[164:165], v[164:165], v[64:65]
    v_pk_mul_f32 v[166:167], v[166:167], v[66:67]
    v_exp_f32 v164, v164
    s_add_u32 m0, s20, 12288
    v_exp_f32 v165, v165
    buffer_load_dwordx4 v20, s[44:47], s27 offen offset:0 lds
    v_exp_f32 v166, v166
    v_exp_f32 v167, v167
    v_pk_fma_f32 v[164:165], v[164:165], v[206:207], v[206:207] op_sel_hi:[1,0,0]
    v_pk_fma_f32 v[166:167], v[166:167], v[206:207], v[206:207] op_sel_hi:[1,0,0]
    v_rcp_f32 v164, v164
    v_rcp_f32 v165, v165
    buffer_load_dwordx4 v21, s[44:47], s27 offen offset:1024 lds
    v_rcp_f32 v166, v166
    v_rcp_f32 v167, v167
    v_pk_mul_f32 v[164:165], v[164:165], v[64:65]
    v_pk_mul_f32 v[166:167], v[166:167], v[66:67]
    v_cvt_pk_bf16_f32 v174, v164, v165
    v_cvt_pk_bf16_f32 v175, v166, v167
    s_cmp_eq_u32 s71, 0
    s_cbranch_scc1 L_slow_46
    buffer_store_dwordx4 v[168:171], v8, s[32:35], s75 offen offset:0
    buffer_store_dwordx4 v[172:175], v8, s[32:35], s75 offen offset:1024
L_join_47:
    s_cmp_eq_u32 s91, 14
    s_cbranch_scc1 L_g3last
    v_pk_mul_f32 v[152:153], v[68:69], v[68:69]
    v_pk_mul_f32 v[154:155], v[70:71], v[70:71]
    buffer_load_dwordx4 v22, s[44:47], s27 offen offset:2048 lds
    v_pk_mul_f32 v[156:157], v[72:73], v[72:73]
    v_pk_mul_f32 v[158:159], v[74:75], v[74:75]
    v_pk_mul_f32 v[160:161], v[76:77], v[76:77]
    v_pk_mul_f32 v[162:163], v[78:79], v[78:79]
    v_pk_mul_f32 v[164:165], v[80:81], v[80:81]
    v_pk_mul_f32 v[166:167], v[82:83], v[82:83]
    v_pk_fma_f32 v[152:153], v[152:153], v[204:205], v[204:205] op_sel:[0,0,1] op_sel_hi:[1,0,1]
    v_pk_fma_f32 v[154:155], v[154:155], v[204:205], v[204:205] op_sel:[0,0,1] op_sel_hi:[1,0,1]
    v_pk_fma_f32 v[156:157], v[156:157], v[204:205], v[204:205] op_sel:[0,0,1] op_sel_hi:[1,0,1]
    v_pk_fma_f32 v[158:159], v[158:159], v[204:205], v[204:205] op_sel:[0,0,1] op_sel_hi:[1,0,1]
    buffer_load_dwordx4 v23, s[44:47], s27 offen offset:3072 lds
    v_pk_fma_f32 v[160:161], v[160:161], v[204:205], v[204:205] op_sel:[0,0,1] op_sel_hi:[1,0,1]
    v_pk_fma_f32 v[162:163], v[162:163], v[204:205], v[204:205] op_sel:[0,0,1] op_sel_hi:[1,0,1]
    v_pk_fma_f32 v[164:165], v[164:165], v[204:205], v[204:205] op_sel:[0,0,1] op_sel_hi:[1,0,1]
    v_pk_fma_f32 v[166:167], v[166:167], v[204:205], v[204:205] op_sel:[0,0,1] op_sel_hi:[1,0,1]
    v_pk_mul_f32 v[152:153], v[152:153], v[68:69]
    v_pk_mul_f32 v[154:155], v[154:155], v[70:71]
    s_add_u32 m0, s21, 49152
    v_pk_mul_f32 v[156:157], v[156:157], v[72:73]
    v_pk_mul_f32 v[158:159], v[158:159], v[74:75]
    v_pk_mul_f32 v[160:161], v[160:161], v[76:77]
    buffer_load_dwordx4 v20, s[44:47], s60 offen offset:0 lds
    v_pk_mul_f32 v[162:163], v[162:163], v[78:79]
    v_pk_mul_f32 v[164:165], v[164:165], v[80:81]
    v_pk_mul_f32 v[166:167], v[166:167], v[82:83]
    v_exp_f32 v152, v152
    v_exp_f32 v153, v153
    v_exp_f32 v154, v154
    v_exp_f32 v155, v155
    buffer_load_dwordx4 v21, s[44:47], s60 offen offset:1024 lds
    v_exp_f32 v156, v156
    v_exp_f32 v157, v157
    v_exp_f32 v158, v158
    v_exp_f32 v159, v159
    v_exp_f32 v160, v160
    buffer_load_dwordx4 v22, s[44:47], s60 offen offset:2048 lds
    v_exp_f32 v161, v161
    v_exp_f32 v162, v162
    v_exp_f32 v163, v163
    v_exp_f32 v164, v164
    v_exp_f32 v165, v165
    buffer_load_dwordx4 v23, s[44:47], s60 offen offset:3072 lds
    v_exp_f32 v166, v166
    v_exp_f32 v167, v167
    v_pk_fma_f32 v[152:153], v[152:153], v[206:207], v[206:207] op_sel_hi:[1,0,0]
    v_pk_fma_f32 v[154:155], v[154:155], v[206:207], v[206:207] op_sel_hi:[1,0,0]
    s_add_u32 m0, s21, 53248
    v_pk_fma_f32 v[156:157], v[156:157], v[206:207], v[206:207] op_sel_hi:[1,0,0]
    v_pk_fma_f32 v[158:159], v[158:159], v[206:207], v[206:207] op_sel_hi:[1,0,0]
    v_pk_fma_f32 v[160:161], v[160:161], v[206:207], v[206:207] op_sel_hi:[1,0,0]
    buffer_load_dwordx4 v20, s[44:47], s61 offen offset:0 lds
    v_pk_fma_f32 v[162:163], v[162:163], v[206:207], v[206:207] op_sel_hi:[1,0,0]
    v_pk_fma_f32 v[164:165], v[164:165], v[206:207], v[206:207] op_sel_hi:[1,0,0]
    v_pk_fma_f32 v[166:167], v[166:167], v[206:207], v[206:207] op_sel_hi:[1,0,0]
    v_rcp_f32 v152, v152
    v_rcp_f32 v153, v153
    v_rcp_f32 v154, v154
    v_rcp_f32 v155, v155
    buffer_load_dwordx4 v21, s[44:47], s61 offen offset:1024 lds
    v_rcp_f32 v156, v156
    v_rcp_f32 v157, v157
    v_rcp_f32 v158, v158
    s_add_u32 m0, s21, 73728
    v_rcp_f32 v159, v159
    v_rcp_f32 v160, v160
    buffer_load_dwordx4 v20, s[44:47], s62 offen offset:0 lds
    v_rcp_f32 v161, v161
    v_rcp_f32 v162, v162
    v_rcp_f32 v163, v163
    v_rcp_f32 v164, v164
    v_rcp_f32 v165, v165
    buffer_load_dwordx4 v21, s[44:47], s62 offen offset:1024 lds
    v_rcp_f32 v166, v166
    v_rcp_f32 v167, v167
    v_pk_mul_f32 v[152:153], v[152:153], v[68:69]
    v_pk_mul_f32 v[154:155], v[154:155], v[70:71]
    v_pk_mul_f32 v[156:157], v[156:157], v[72:73]
    v_pk_mul_f32 v[158:159], v[158:159], v[74:75]
    v_pk_mul_f32 v[160:161], v[160:161], v[76:77]
    v_pk_mul_f32 v[162:163], v[162:163], v[78:79]
    buffer_load_dwordx4 v22, s[44:47], s62 offen offset:2048 lds
    v_pk_mul_f32 v[164:165], v[164:165], v[80:81]
    v_pk_mul_f32 v[166:167], v[166:167], v[82:83]
    v_cvt_pk_bf16_f32 v176, v152, v153
    v_cvt_pk_bf16_f32 v177, v154, v155
    v_cvt_pk_bf16_f32 v178, v156, v157
    v_cvt_pk_bf16_f32 v179, v158, v159
    v_cvt_pk_bf16_f32 v180, v160, v161
    v_cvt_pk_bf16_f32 v181, v162, v163
    v_cvt_pk_bf16_f32 v182, v164, v165
    v_cvt_pk_bf16_f32 v183, v166, v167
    buffer_load_dwordx4 v23, s[44:47], s62 offen offset:3072 lds
    s_cmp_eq_u32 s71, 0
    s_cbranch_scc1 L_slow_48
    buffer_store_dwordx4 v[176:179], v8, s[32:35], s75 offen offset:2048
    buffer_store_dwordx4 v[180:183], v8, s[32:35], s75 offen offset:3072
L_join_49:
    s_add_u32 s75, s75, 4096
    v_pk_mul_f32 v[152:153], v[84:85], v[84:85]
    v_pk_mul_f32 v[154:155], v[86:87], v[86:87]
    v_pk_mul_f32 v[156:157], v[88:89], v[88:89]
    v_pk_mul_f32 v[158:159], v[90:91], v[90:91]
    v_pk_mul_f32 v[160:161], v[92:93], v[92:93]
    v_pk_mul_f32 v[162:163], v[94:95], v[94:95]
    s_add_u32 m0, s21, 77824
    v_pk_mul_f32 v[164:165], v[96:97], v[96:97]
    v_pk_mul_f32 v[166:167], v[98:99], v[98:99]
    v_pk_fma_f32 v[152:153], v[152:153], v[204:205], v[204:205] op_sel:[0,0,1] op_sel_hi:[1,0,1]
    buffer_load_dwordx4 v20, s[44:47], s63 offen offset:0 lds
    v_pk_fma_f32 v[154:155], v[154:155], v[204:205], v[204:205] op_sel:[0,0,1] op_sel_hi:[1,0,1]
    v_pk_fma_f32 v[156:157], v[156:157], v[204:205], v[204:205] op_sel:[0,0,1] op_sel_hi:[1,0,1]
    v_pk_fma_f32 v[158:159], v[158:159], v[204:205], v[204:205] op_sel:[0,0,1] op_sel_hi:[1,0,1]
    v_pk_fma_f32 v[160:161], v[160:161], v[204:205], v[204:205] op_sel:[0,0,1] op_sel_hi:[1,0,1]
    v_pk_fma_f32 v[162:163], v[162:163], v[204:205], v[204:205] op_sel:[0,0,1] op_sel_hi:[1,0,1]
    v_pk_fma_f32 v[164:165], v[164:165], v[204:205], v[204:205] op_sel:[0,0,1] op_sel_hi:[1,0,1]
    v_pk_fma_f32 v[166:167], v[166:167], v[204:205], v[204:205] op_sel:[0,0,1] op_sel_hi:[1,0,1]
    v_pk_mul_f32 v[152:153], v[152:153], v[84:85]
    v_pk_mul_f32 v[154:155], v[154:155], v[86:87]
    v_pk_mul_f32 v[156:157], v[156:157], v[88:89]
    buffer_load_dwordx4 v21, s[44:47], s63 offen offset:1024 lds
    v_pk_mul_f32 v[158:159], v[158:159], v[90:91]
    v_pk_mul_f32 v[160:161], v[160:161], v[92:93]
    v_pk_mul_f32 v[162:163], v[162:163], v[94:95]
    v_pk_mul_f32 v[164:165], v[164:165], v[96:97]
    v_pk_mul_f32 v[166:167], v[166:167], v[98:99]
    v_exp_f32 v152, v152
    v_exp_f32 v153, v153
    v_exp_f32 v154, v154
    v_exp_f32 v155, v155
    v_exp_f32 v156, v156
    v_exp_f32 v157, v157
    v_exp_f32 v158, v158
    v_exp_f32 v159, v159
    v_exp_f32 v160, v160
    v_exp_f32 v161, v161
    v_exp_f32 v162, v162
    v_exp_f32 v163, v163
    v_exp_f32 v164, v164
    v_exp_f32 v165, v165
    v_exp_f32 v166, v166
    v_exp_f32 v167, v167
    v_pk_fma_f32 v[152:153], v[152:153], v[206:207], v[206:207] op_sel_hi:[1,0,0]
    v_pk_fma_f32 v[154:155], v[154:155], v[206:207], v[206:207] op_sel_hi:[1,0,0]
    v_pk_fma_f32 v[156:157], v[156:157], v[206:207], v[206:207] op_sel_hi:[1,0,0]
    v_pk_fma_f32 v[158:159], v[158:159], v[206:207], v[206:207] op_sel_hi:[1,0,0]
    v_pk_fma_f32 v[160:161], v[160:161], v[206:207], v[206:207] op_sel_hi:[1,0,0]
    v_pk_fma_f32 v[162:163], v[162:163], v[206:207], v[206:207] op_sel_hi:[1,0,0]
    v_pk_fma_f32 v[164:165], v[164:165], v[206:207], v[206:207] op_sel_hi:[1,0,0]
    v_pk_fma_f32 v[166:167], v[166:167], v[206:207], v[206:207] op_sel_hi:[1,0,0]
    v_rcp_f32 v152, v152
    v_rcp_f32 v153, v153
    v_rcp_f32 v154, v154
    v_rcp_f32 v155, v155
    v_rcp_f32 v156, v156
    v_rcp_f32 v157, v157
    v_rcp_f32 v158, v158
    v_rcp_f32 v159, v159
    v_rcp_f32 v160, v160
    v_rcp_f32 v161, v161
    v_rcp_f32 v162, v162
    v_rcp_f32 v163, v163
    v_rcp_f32 v164, v164
    v_rcp_f32 v165, v165
    v_rcp_f32 v166, v166
    v_rcp_f32 v167, v167
    v_pk_mul_f32 v[152:153], v[152:153], v[84:85]
    v_pk_mul_f32 v[154:155], v[154:155], v[86:87]
    v_pk_mul_f32 v[156:157], v[156:157], v[88:89]
    v_pk_mul_f32 v[158:159], v[158:159], v[90:91]
    v_pk_mul_f32 v[160:161], v[160:161], v[92:93]
    v_pk_mul_f32 v[162:163], v[162:163], v[94:95]
    v_pk_mul_f32 v[164:165], v[164:165], v[96:97]
    v_pk_mul_f32 v[166:167], v[166:167], v[98:99]
    v_cvt_pk_bf16_f32 v184, v152, v153
    v_cvt_pk_bf16_f32 v185, v154, v155
    v_cvt_pk_bf16_f32 v186, v156, v157
    v_cvt_pk_bf16_f32 v187, v158, v159
    v_cvt_pk_bf16_f32 v188, v160, v161
    v_cvt_pk_bf16_f32 v189, v162, v163
    v_cvt_pk_bf16_f32 v190, v164, v165
    v_cvt_pk_bf16_f32 v191, v166, v167
    s_cmp_eq_u32 s71, 0
    s_cbranch_scc1 L_slow_50
    buffer_store_dwordx4 v[184:187], v8, s[32:35], s75 offen offset:0
    buffer_store_dwordx4 v[188:191], v8, s[32:35], s75 offen offset:1024
L_join_51:
L_g3done:
    s_lshl_b32 s73, s90, 7
    s_lshl_b32 s74, s91, 2
    s_add_u32 s73, s73, s74
    s_add_u32 s73, s73, 32768
    v_mov_b32 v209, s70
    v_mov_b32 v208, 0
    s_waitcnt vmcnt(0)
    s_mov_b64 exec, 1
    s_cmp_eq_u32 s71, 0
    s_cbranch_scc1 L_slow_52
    buffer_store_dword v209, v208, s[32:35], s73 offen
L_join_53:
    s_mov_b64 exec, -1
L_p4:
    v_lshrrev_b32 v4, 2, v2
    v_lshl_add_u32 v4, v6, 2, v4
    v_lshlrev_b32 v4, 7, v4
    v_lshrrev_b32 v12, 3, v2
    v_lshl_add_u32 v4, v12, 6, v4
    v_lshl_add_u32 v4, v7, 5, v4
    v_and_b32 v12, 3, v2
    v_lshl_add_u32 v4, v12, 3, v4
    v_add_u32 v12, s20, v4
    v_xor_b32 v13, 64, v12
    ds_read_b64_tr_b16 v[116:117], v12 offset:0
    ds_read_b64_tr_b16 v[118:119], v12 offset:1024
    ds_read_b64_tr_b16 v[120:121], v13 offset:0
    ds_read_b64_tr_b16 v[122:123], v13 offset:1024
    ds_read_b64_tr_b16 v[124:125], v12 offset:2048
    ds_read_b64_tr_b16 v[126:127], v12 offset:3072
    ds_read_b64_tr_b16 v[128:129], v13 offset:2048
    ds_read_b64_tr_b16 v[130:131], v13 offset:3072
    v_add_u32 v14, s21, v4
    v_xor_b32 v15, 64, v14
    v_add_u32 v16, 49152, v14
    v_xor_b32 v17, 64, v16
    s_lshl_b32 s76, s66, 8
    s_add_u32 s76, s76, 32768
    v_lshlrev_b32 v4, 2, v2
    v_lshl_add_u32 v4, v3, 7, v4
    s_waitcnt lgkmcnt(0)
    s_add_u32 m0, s20, 0
    s_nop 0
    buffer_load_dwordx4 v20, s[44:47], s12 offen offset:0 lds
    buffer_load_dwordx4 v21, s[44:47], s12 offen offset:1024 lds
    buffer_load_dwordx4 v22, s[44:47], s12 offen offset:2048 lds
    buffer_load_dwordx4 v23, s[44:47], s12 offen offset:3072 lds
    v_lshlrev_b32 v164, 16, v44
    v_and_b32 v165, 0xffff0000, v44
    v_lshlrev_b32 v180, 16, v36
    v_and_b32 v181, 0xffff0000, v36
    v_lshlrev_b32 v166, 16, v45
    v_and_b32 v167, 0xffff0000, v45
    v_lshlrev_b32 v182, 16, v37
    v_and_b32 v183, 0xffff0000, v37
    v_lshlrev_b32 v168, 16, v46
    v_and_b32 v169, 0xffff0000, v46
    v_lshlrev_b32 v184, 16, v38
    v_and_b32 v185, 0xffff0000, v38
    v_lshlrev_b32 v170, 16, v47
    v_and_b32 v171, 0xffff0000, v47
    v_lshlrev_b32 v186, 16, v39
    v_and_b32 v187, 0xffff0000, v39
    v_lshlrev_b32 v172, 16, v48
    v_and_b32 v173, 0xffff0000, v48
    v_lshlrev_b32 v188, 16, v40
    v_and_b32 v189, 0xffff0000, v40
    v_lshlrev_b32 v174, 16, v49
    v_and_b32 v175, 0xffff0000, v49
    v_lshlrev_b32 v190, 16, v41
    v_and_b32 v191, 0xffff0000, v41
    v_lshlrev_b32 v176, 16, v50
    v_and_b32 v177, 0xffff0000, v50
    v_lshlrev_b32 v192, 16, v42
    v_and_b32 v193, 0xffff0000, v42
    v_lshlrev_b32 v178, 16, v51
    v_and_b32 v179, 0xffff0000, v51
    v_lshlrev_b32 v194, 16, v43
    v_and_b32 v195, 0xffff0000, v43
    v_pk_add_f32 v[164:165], v[164:165], v[180:181]
    v_pk_add_f32 v[166:167], v[166:167], v[182:183]
    v_pk_add_f32 v[168:169], v[168:169], v[184:185]
    v_pk_add_f32 v[170:171], v[170:171], v[186:187]
    v_pk_add_f32 v[172:173], v[172:173], v[188:189]
    v_pk_add_f32 v[174:175], v[174:175], v[190:191]
    v_pk_add_f32 v[176:177], v[176:177], v[192:193]
    v_pk_add_f32 v[178:179], v[178:179], v[194:195]
    s_mov_b32 s78, 0
    s_mov_b64 exec, 0x7fff7fff
L_poll_54:
    buffer_load_dword v208, v4, s[32:35], s76 offen sc1
    s_add_u32 s78, s78, 1
    s_waitcnt vmcnt(0)
    v_cmp_ne_u32 vcc, s70, v208
    s_cmp_lt_u32 s78, 60000
    s_cbranch_scc0 L_pollx_55
    s_cbranch_vccnz L_poll_54
L_pollx_55:
    s_mov_b64 exec, -1
    s_add_u32 s79, s16, 0
    s_add_u32 s17, s16, 4294877184
    s_min_u32 s79, s79, s17
    buffer_load_dwordx4 a[0:3], v8, s[48:51], s79 offen offset:0 sc1
    buffer_load_dwordx4 a[4:7], v8, s[52:55], s79 offen offset:0 sc1
    buffer_load_dwordx4 a[8:11], v8, s[48:51], s79 offen offset:1024 sc1
    buffer_load_dwordx4 a[12:15], v8, s[52:55], s79 offen offset:1024 sc1
    buffer_load_dwordx4 a[16:19], v8, s[48:51], s79 offen offset:2048 sc1
    buffer_load_dwordx4 a[20:23], v8, s[52:55], s79 offen offset:2048 sc1
    buffer_load_dwordx4 a[24:27], v8, s[48:51], s79 offen offset:3072 sc1
    buffer_load_dwordx4 a[28:31], v8, s[52:55], s79 offen offset:3072 sc1
    s_add_u32 s79, s16, 4096
    s_add_u32 s17, s16, 4294881280
    s_min_u32 s79, s79, s17
    buffer_load_dwordx4 a[32:35], v8, s[48:51], s79 offen offset:0 sc1
    buffer_load_dwordx4 a[36:39], v8, s[52:55], s79 offen offset:0 sc1
    buffer_load_dwordx4 a[40:43], v8, s[48:51], s79 offen offset:1024 sc1
    buffer_load_dwordx4 a[44:47], v8, s[52:55], s79 offen offset:1024 sc1
    s_waitcnt vmcnt(10) lgkmcnt(4)
    v_mfma_f32_32x32x16_bf16 v[100:115], v[120:123], a[4:7], 0
    ds_read_b64_tr_b16 v[132:133], v12 offset:4096
    buffer_load_dwordx4 a[48:51], v8, s[48:51], s79 offen offset:2048 sc1
    v_mfma_f32_32x32x16_bf16 v[84:99], v[120:123], a[0:3], 0
    ds_read_b64_tr_b16 v[134:135], v12 offset:5120
    v_mfma_f32_32x32x16_bf16 v[68:83], v[116:119], a[4:7], 0
    ds_read_b64_tr_b16 v[136:137], v13 offset:4096
    buffer_load_dwordx4 a[52:55], v8, s[52:55], s79 offen offset:2048 sc1
    v_mfma_f32_32x32x16_bf16 v[52:67], v[116:119], a[0:3], 0
    ds_read_b64_tr_b16 v[138:139], v13 offset:5120
    s_waitcnt vmcnt(10) lgkmcnt(4)
    v_mfma_f32_32x32x16_bf16 v[100:115], v[128:131], a[12:15], v[100:115]
    ds_read_b64_tr_b16 v[140:141], v12 offset:6144
    buffer_load_dwordx4 a[56:59], v8, s[48:51], s79 offen offset:3072 sc1
    v_mfma_f32_32x32x16_bf16 v[84:99], v[128:131], a[8:11], v[84:99]
    ds_read_b64_tr_b16 v[142:143], v12 offset:7168
    v_mfma_f32_32x32x16_bf16 v[68:83], v[124:127], a[12:15], v[68:83]
    ds_read_b64_tr_b16 v[144:145], v13 offset:6144
    buffer_load_dwordx4 a[60:63], v8, s[52:55], s79 offen offset:3072 sc1
    v_mfma_f32_32x32x16_bf16 v[52:67], v[124:127], a[8:11], v[52:67]
    ds_read_b64_tr_b16 v[146:147], v13 offset:7168
    s_waitcnt vmcnt(10) lgkmcnt(4)
    v_mfma_f32_32x32x16_bf16 v[100:115], v[136:139], a[20:23], v[100:115]
    ds_read_b64_tr_b16 v[116:117], v12 offset:8192
    s_add_u32 s79, s16, 8192
    s_add_u32 s17, s16, 4294885376
    s_min_u32 s79, s79, s17
    buffer_load_dwordx4 a[64:67], v8, s[48:51], s79 offen offset:0 sc1
    s_lshl_b32 s73, s66, 16
    v_mfma_f32_32x32x16_bf16 v[84:99], v[136:139], a[16:19], v[84:99]
    ds_read_b64_tr_b16 v[118:119], v12 offset:9216
    s_lshl_b32 s74, s67, 7
    s_add_u32 s73, s73, s74
    s_add_u32 s73, s73, s20
    v_lshlrev_b32 v4, 10, v2
    v_lshl_add_u32 v4, v7, 5, v4
    v_mfma_f32_32x32x16_bf16 v[68:83], v[132:135], a[20:23], v[68:83]
    ds_read_b64_tr_b16 v[120:121], v13 offset:8192
    buffer_load_dwordx4 a[68:71], v8, s[52:55], s79 offen offset:0 sc1
    v_lshl_add_u32 v4, v6, 4, v4
    v_add_u32 v10, s20, v8
    v_lshlrev_b32 v11, 11, v7
    v_lshl_add_u32 v11, v6, 10, v11
    v_mfma_f32_32x32x16_bf16 v[52:67], v[132:135], a[16:19], v[52:67]
    ds_read_b64_tr_b16 v[122:123], v13 offset:9216
    v_lshl_add_u32 v11, v2, 4, v11
    s_lshl_b32 s74, s93, 12
    s_lshl_b32 s17, s92, 8
    s_add_u32 s74, s74, s17
    v_add_u32 v11, s74, v11
    s_waitcnt vmcnt(10) lgkmcnt(4)
    v_mfma_f32_32x32x16_bf16 v[100:115], v[144:147], a[28:31], v[100:115]
    ds_read_b64_tr_b16 v[124:125], v12 offset:10240
    buffer_load_dwordx4 a[72:75], v8, s[48:51], s79 offen offset:1024 sc1
    v_mfma_f32_32x32x16_bf16 v[84:99], v[144:147], a[24:27], v[84:99]
    ds_read_b64_tr_b16 v[126:127], v12 offset:11264
    v_mfma_f32_32x32x16_bf16 v[68:83], v[140:143], a[28:31], v[68:83]
    ds_read_b64_tr_b16 v[128:129], v13 offset:10240
    buffer_load_dwordx4 a[76:79], v8, s[52:55], s79 offen offset:1024 sc1
    v_mfma_f32_32x32x16_bf16 v[52:67], v[140:143], a[24:27], v[52:67]
    ds_read_b64_tr_b16 v[130:131], v13 offset:11264
    s_waitcnt vmcnt(10) lgkmcnt(4)
    v_mfma_f32_32x32x16_bf16 v[100:115], v[120:123], a[36:39], v[100:115]
    ds_read_b64_tr_b16 v[132:133], v12 offset:12288
    buffer_load_dwordx4 a[80:83], v8, s[48:51], s79 offen offset:2048 sc1
    v_mfma_f32_32x32x16_bf16 v[84:99], v[120:123], a[32:35], v[84:99]
    ds_read_b64_tr_b16 v[134:135], v12 offset:13312
    v_mfma_f32_32x32x16_bf16 v[68:83], v[116:119], a[36:39], v[68:83]
    ds_read_b64_tr_b16 v[136:137], v13 offset:12288
    buffer_load_dwordx4 a[84:87], v8, s[52:55], s79 offen offset:2048 sc1
    v_mfma_f32_32x32x16_bf16 v[52:67], v[116:119], a[32:35], v[52:67]
    ds_read_b64_tr_b16 v[138:139], v13 offset:13312
    s_waitcnt vmcnt(10) lgkmcnt(4)
    v_mfma_f32_32x32x16_bf16 v[100:115], v[128:131], a[44:47], v[100:115]
    ds_read_b64_tr_b16 v[140:141], v12 offset:14336
    buffer_load_dwordx4 a[88:91], v8, s[48:51], s79 offen offset:3072 sc1
    v_mfma_f32_32x32x16_bf16 v[84:99], v[128:131], a[40:43], v[84:99]
    ds_read_b64_tr_b16 v[142:143], v12 offset:15360
    v_mfma_f32_32x32x16_bf16 v[68:83], v[124:127], a[44:47], v[68:83]
    ds_read_b64_tr_b16 v[144:145], v13 offset:14336
    buffer_load_dwordx4 a[92:95], v8, s[52:55], s79 offen offset:3072 sc1
    v_mfma_f32_32x32x16_bf16 v[52:67], v[124:127], a[40:43], v[52:67]
    ds_read_b64_tr_b16 v[146:147], v13 offset:15360
    s_waitcnt vmcnt(10) lgkmcnt(4)
    v_mfma_f32_32x32x16_bf16 v[100:115], v[136:139], a[52:55], v[100:115]
    ds_read_b64_tr_b16 v[116:117], v14 offset:0
    s_add_u32 s79, s16, 12288
    s_add_u32 s17, s16, 4294889472
    s_min_u32 s79, s79, s17
    buffer_load_dwordx4 a[96:99], v8, s[48:51], s79 offen offset:0 sc1
    v_mfma_f32_32x32x16_bf16 v[84:99], v[136:139], a[48:51], v[84:99]
    ds_read_b64_tr_b16 v[118:119], v14 offset:1024
    v_mfma_f32_32x32x16_bf16 v[68:83], v[132:135], a[52:55], v[68:83]
    ds_read_b64_tr_b16 v[120:121], v15 offset:0
    buffer_load_dwordx4 a[100:103], v8, s[52:55], s79 offen offset:0 sc1
    v_mfma_f32_32x32x16_bf16 v[52:67], v[132:135], a[48:51], v[52:67]
    ds_read_b64_tr_b16 v[122:123], v15 offset:1024
    s_waitcnt vmcnt(10) lgkmcnt(4)
    v_mfma_f32_32x32x16_bf16 v[100:115], v[144:147], a[60:63], v[100:115]
    ds_read_b64_tr_b16 v[124:125], v14 offset:2048
    buffer_load_dwordx4 a[104:107], v8, s[48:51], s79 offen offset:1024 sc1
    v_mfma_f32_32x32x16_bf16 v[84:99], v[144:147], a[56:59], v[84:99]
    ds_read_b64_tr_b16 v[126:127], v14 offset:3072
    v_mfma_f32_32x32x16_bf16 v[68:83], v[140:143], a[60:63], v[68:83]
    ds_read_b64_tr_b16 v[128:129], v15 offset:2048
    buffer_load_dwordx4 a[108:111], v8, s[52:55], s79 offen offset:1024 sc1
    v_mfma_f32_32x32x16_bf16 v[52:67], v[140:143], a[56:59], v[52:67]
    ds_read_b64_tr_b16 v[130:131], v15 offset:3072
    s_waitcnt vmcnt(10) lgkmcnt(4)
    v_mfma_f32_32x32x16_bf16 v[100:115], v[120:123], a[68:71], v[100:115]
    ds_read_b64_tr_b16 v[132:133], v14 offset:4096
    buffer_load_dwordx4 a[112:115], v8, s[48:51], s79 offen offset:2048 sc1
    v_mfma_f32_32x32x16_bf16 v[84:99], v[120:123], a[64:67], v[84:99]
    ds_read_b64_tr_b16 v[134:135], v14 offset:5120
    v_mfma_f32_32x32x16_bf16 v[68:83], v[116:119], a[68:71], v[68:83]
    ds_read_b64_tr_b16 v[136:137], v15 offset:4096
    buffer_load_dwordx4 a[116:119], v8, s[52:55], s79 offen offset:2048 sc1
    v_mfma_f32_32x32x16_bf16 v[52:67], v[116:119], a[64:67], v[52:67]
    ds_read_b64_tr_b16 v[138:139], v15 offset:5120
    s_waitcnt vmcnt(10) lgkmcnt(4)
    v_mfma_f32_32x32x16_bf16 v[100:115], v[128:131], a[76:79], v[100:115]
    ds_read_b64_tr_b16 v[140:141], v14 offset:24576
    buffer_load_dwordx4 a[120:123], v8, s[48:51], s79 offen offset:3072 sc1
    v_mfma_f32_32x32x16_bf16 v[84:99], v[128:131], a[72:75], v[84:99]
    ds_read_b64_tr_b16 v[142:143], v14 offset:25600
    v_mfma_f32_32x32x16_bf16 v[68:83], v[124:127], a[76:79], v[68:83]
    ds_read_b64_tr_b16 v[144:145], v15 offset:24576
    buffer_load_dwordx4 a[124:127], v8, s[52:55], s79 offen offset:3072 sc1
    v_mfma_f32_32x32x16_bf16 v[52:67], v[124:127], a[72:75], v[52:67]
    ds_read_b64_tr_b16 v[146:147], v15 offset:25600
    s_waitcnt vmcnt(10) lgkmcnt(4)
    v_mfma_f32_32x32x16_bf16 v[100:115], v[136:139], a[84:87], v[100:115]
    ds_read_b64_tr_b16 v[116:117], v14 offset:26624
    s_add_u32 s79, s16, 16384
    s_add_u32 s17, s16, 4294893568
    s_min_u32 s79, s79, s17
    buffer_load_dwordx4 a[128:131], v8, s[48:51], s79 offen offset:0 sc1
    v_mfma_f32_32x32x16_bf16 v[84:99], v[136:139], a[80:83], v[84:99]
    ds_read_b64_tr_b16 v[118:119], v14 offset:27648
    v_mfma_f32_32x32x16_bf16 v[68:83], v[132:135], a[84:87], v[68:83]
    ds_read_b64_tr_b16 v[120:121], v15 offset:26624
    buffer_load_dwordx4 a[132:135], v8, s[52:55], s79 offen offset:0 sc1
    v_mfma_f32_32x32x16_bf16 v[52:67], v[132:135], a[80:83], v[52:67]
    ds_read_b64_tr_b16 v[122:123], v15 offset:27648
    s_waitcnt vmcnt(10) lgkmcnt(4)
    v_mfma_f32_32x32x16_bf16 v[100:115], v[144:147], a[92:95], v[100:115]
    ds_read_b64_tr_b16 v[124:125], v14 offset:28672
    buffer_load_dwordx4 a[136:139], v8, s[48:51], s79 offen offset:1024 sc1
    v_mfma_f32_32x32x16_bf16 v[84:99], v[144:147], a[88:91], v[84:99]
    ds_read_b64_tr_b16 v[126:127], v14 offset:29696
    v_mfma_f32_32x32x16_bf16 v[68:83], v[140:143], a[92:95], v[68:83]
    ds_read_b64_tr_b16 v[128:129], v15 offset:28672
    buffer_load_dwordx4 a[140:143], v8, s[52:55], s79 offen offset:1024 sc1
    v_mfma_f32_32x32x16_bf16 v[52:67], v[140:143], a[88:91], v[52:67]
    ds_read_b64_tr_b16 v[130:131], v15 offset:29696
    s_waitcnt vmcnt(10) lgkmcnt(4)
    v_mfma_f32_32x32x16_bf16 v[100:115], v[120:123], a[100:103], v[100:115]
    ds_read_b64_tr_b16 v[132:133], v16 offset:0
    buffer_load_dwordx4 a[144:147], v8, s[48:51], s79 offen offset:2048 sc1
    v_mfma_f32_32x32x16_bf16 v[84:99], v[120:123], a[96:99], v[84:99]
    ds_read_b64_tr_b16 v[134:135], v16 offset:1024
    v_mfma_f32_32x32x16_bf16 v[68:83], v[116:119], a[100:103], v[68:83]
    ds_read_b64_tr_b16 v[136:137], v17 offset:0
    buffer_load_dwordx4 a[148:151], v8, s[52:55], s79 offen offset:2048 sc1
    v_mfma_f32_32x32x16_bf16 v[52:67], v[116:119], a[96:99], v[52:67]
    ds_read_b64_tr_b16 v[138:139], v17 offset:1024
    s_waitcnt vmcnt(10) lgkmcnt(4)
    v_mfma_f32_32x32x16_bf16 v[100:115], v[128:131], a[108:111], v[100:115]
    ds_read_b64_tr_b16 v[140:141], v16 offset:2048
    buffer_load_dwordx4 a[152:155], v8, s[48:51], s79 offen offset:3072 sc1
    v_mfma_f32_32x32x16_bf16 v[84:99], v[128:131], a[104:107], v[84:99]
    ds_read_b64_tr_b16 v[142:143], v16 offset:3072
    v_mfma_f32_32x32x16_bf16 v[68:83], v[124:127], a[108:111], v[68:83]
    ds_read_b64_tr_b16 v[144:145], v17 offset:2048
    buffer_load_dwordx4 a[156:159], v8, s[52:55], s79 offen offset:3072 sc1
    v_mfma_f32_32x32x16_bf16 v[52:67], v[124:127], a[104:107], v[52:67]
    ds_read_b64_tr_b16 v[146:147], v17 offset:3072
    s_waitcnt vmcnt(10) lgkmcnt(4)
    v_mfma_f32_32x32x16_bf16 v[100:115], v[136:139], a[116:119], v[100:115]
    ds_read_b64_tr_b16 v[116:117], v16 offset:4096
    s_add_u32 s79, s16, 20480
    s_add_u32 s17, s16, 4294897664
    s_min_u32 s79, s79, s17
    buffer_load_dwordx4 a[160:163], v8, s[48:51], s79 offen offset:0 sc1
    v_mfma_f32_32x32x16_bf16 v[84:99], v[136:139], a[112:115], v[84:99]
    ds_read_b64_tr_b16 v[118:119], v16 offset:5120
    v_mfma_f32_32x32x16_bf16 v[68:83], v[132:135], a[116:119], v[68:83]
    ds_read_b64_tr_b16 v[120:121], v17 offset:4096
    buffer_load_dwordx4 a[164:167], v8, s[52:55], s79 offen offset:0 sc1
    v_mfma_f32_32x32x16_bf16 v[52:67], v[132:135], a[112:115], v[52:67]
    ds_read_b64_tr_b16 v[122:123], v17 offset:5120
    s_waitcnt vmcnt(10) lgkmcnt(4)
    v_mfma_f32_32x32x16_bf16 v[100:115], v[144:147], a[124:127], v[100:115]
    ds_read_b64_tr_b16 v[124:125], v16 offset:24576
    buffer_load_dwordx4 a[168:171], v8, s[48:51], s79 offen offset:1024 sc1
    v_mfma_f32_32x32x16_bf16 v[84:99], v[144:147], a[120:123], v[84:99]
    ds_read_b64_tr_b16 v[126:127], v16 offset:25600
    v_mfma_f32_32x32x16_bf16 v[68:83], v[140:143], a[124:127], v[68:83]
    ds_read_b64_tr_b16 v[128:129], v17 offset:24576
    buffer_load_dwordx4 a[172:175], v8, s[52:55], s79 offen offset:1024 sc1
    v_mfma_f32_32x32x16_bf16 v[52:67], v[140:143], a[120:123], v[52:67]
    ds_read_b64_tr_b16 v[130:131], v17 offset:25600
    s_waitcnt vmcnt(10) lgkmcnt(4)
    v_mfma_f32_32x32x16_bf16 v[100:115], v[120:123], a[132:135], v[100:115]
    ds_read_b64_tr_b16 v[132:133], v16 offset:26624
    v_mfma_f32_32x32x16_bf16 v[84:99], v[120:123], a[128:131], v[84:99]
    ds_read_b64_tr_b16 v[134:135], v16 offset:27648
    v_mfma_f32_32x32x16_bf16 v[68:83], v[116:119], a[132:135], v[68:83]
    ds_read_b64_tr_b16 v[136:137], v17 offset:26624
    v_mfma_f32_32x32x16_bf16 v[52:67], v[116:119], a[128:131], v[52:67]
    ds_read_b64_tr_b16 v[138:139], v17 offset:27648
    s_waitcnt vmcnt(8) lgkmcnt(4)
    v_mfma_f32_32x32x16_bf16 v[100:115], v[128:131], a[140:143], v[100:115]
    ds_read_b64_tr_b16 v[140:141], v16 offset:28672
    v_mfma_f32_32x32x16_bf16 v[84:99], v[128:131], a[136:139], v[84:99]
    ds_read_b64_tr_b16 v[142:143], v16 offset:29696
    v_mfma_f32_32x32x16_bf16 v[68:83], v[124:127], a[140:143], v[68:83]
    ds_read_b64_tr_b16 v[144:145], v17 offset:28672
    v_mfma_f32_32x32x16_bf16 v[52:67], v[124:127], a[136:139], v[52:67]
    ds_read_b64_tr_b16 v[146:147], v17 offset:29696
    s_waitcnt vmcnt(6) lgkmcnt(4)
    v_mfma_f32_32x32x16_bf16 v[100:115], v[136:139], a[148:151], v[100:115]
    ds_read_b64_tr_b16 v[116:117], v12 offset:0
    v_mfma_f32_32x32x16_bf16 v[84:99], v[136:139], a[144:147], v[84:99]
    ds_read_b64_tr_b16 v[118:119], v12 offset:1024
    v_mfma_f32_32x32x16_bf16 v[68:83], v[132:135], a[148:151], v[68:83]
    ds_read_b64_tr_b16 v[120:121], v13 offset:0
    v_mfma_f32_32x32x16_bf16 v[52:67], v[132:135], a[144:147], v[52:67]
    ds_read_b64_tr_b16 v[122:123], v13 offset:1024
    s_waitcnt vmcnt(4) lgkmcnt(4)
    v_mfma_f32_32x32x16_bf16 v[100:115], v[144:147], a[156:159], v[100:115]
    ds_read_b64_tr_b16 v[124:125], v12 offset:2048
    v_mfma_f32_32x32x16_bf16 v[84:99], v[144:147], a[152:155], v[84:99]
    ds_read_b64_tr_b16 v[126:127], v12 offset:3072
    v_mfma_f32_32x32x16_bf16 v[68:83], v[140:143], a[156:159], v[68:83]
    ds_read_b64_tr_b16 v[128:129], v13 offset:2048
    v_mfma_f32_32x32x16_bf16 v[52:67], v[140:143], a[152:155], v[52:67]
    ds_read_b64_tr_b16 v[130:131], v13 offset:3072
    s_waitcnt vmcnt(0) lgkmcnt(0)
    v_mfma_f32_32x32x16_bf16 v[100:115], v[120:123], a[164:167], v[100:115]
    v_mfma_f32_32x32x16_bf16 v[100:115], v[128:131], a[172:175], v[100:115]
    v_mfma_f32_32x32x16_bf16 v[84:99], v[120:123], a[160:163], v[84:99]
    v_mfma_f32_32x32x16_bf16 v[84:99], v[128:131], a[168:171], v[84:99]
    v_mfma_f32_32x32x16_bf16 v[68:83], v[116:119], a[164:167], v[68:83]
    v_mfma_f32_32x32x16_bf16 v[68:83], v[124:127], a[172:175], v[68:83]
    s_nop 7
    ds_write_b128 v10, v[100:103] offset:12288
    ds_write_b128 v10, v[104:107] offset:13312
    ds_write_b128 v10, v[108:111] offset:14336
    ds_write_b128 v10, v[112:115] offset:15360
    v_mfma_f32_32x32x16_bf16 v[52:67], v[116:119], a[160:163], v[52:67]
    v_mfma_f32_32x32x16_bf16 v[52:67], v[124:127], a[168:171], v[52:67]
    ds_write_b128 v10, v[84:87] offset:8192
    ds_write_b128 v10, v[88:91] offset:9216
    ds_write_b128 v10, v[92:95] offset:10240
    ds_write_b128 v10, v[96:99] offset:11264
    ds_write_b128 v10, v[68:71] offset:4096
    ds_write_b128 v10, v[72:75] offset:5120
    ds_write_b128 v10, v[76:79] offset:6144
    ds_write_b128 v10, v[80:83] offset:7168
    s_nop 3
    ds_write_b128 v10, v[52:55] offset:0
    ds_write_b128 v10, v[56:59] offset:1024
    ds_write_b128 v10, v[60:63] offset:2048
    ds_write_b128 v10, v[64:67] offset:3072
    s_waitcnt lgkmcnt(0)
    s_barrier
    ds_read_b128 v[52:55], v11 offset:0
    ds_read_b128 v[56:59], v11 offset:512
    ds_read_b128 v[60:63], v11 offset:8192
    ds_read_b128 v[64:67], v11 offset:8704
    ds_read_b128 v[68:71], v11 offset:16384
    ds_read_b128 v[72:75], v11 offset:16896
    ds_read_b128 v[76:79], v11 offset:24576
    ds_read_b128 v[80:83], v11 offset:25088
    ds_read_b128 v[84:87], v11 offset:32768
    ds_read_b128 v[88:91], v11 offset:33280
    ds_read_b128 v[92:95], v11 offset:40960
    ds_read_b128 v[96:99], v11 offset:41472
    ds_read_b128 v[100:103], v11 offset:49152
    ds_read_b128 v[104:107], v11 offset:49664
    ds_read_b128 v[108:111], v11 offset:57344
    ds_read_b128 v[112:115], v11 offset:57856
    s_waitcnt lgkmcnt(12)
    v_pk_add_f32 v[164:165], v[164:165], v[52:53]
    v_pk_add_f32 v[166:167], v[166:167], v[54:55]
    v_pk_add_f32 v[168:169], v[168:169], v[56:57]
    v_pk_add_f32 v[170:171], v[170:171], v[58:59]
    v_pk_add_f32 v[172:173], v[172:173], v[60:61]
    v_pk_add_f32 v[174:175], v[174:175], v[62:63]
    v_pk_add_f32 v[176:177], v[176:177], v[64:65]
    v_pk_add_f32 v[178:179], v[178:179], v[66:67]
    s_waitcnt lgkmcnt(8)
    v_pk_add_f32 v[164:165], v[164:165], v[68:69]
    v_pk_add_f32 v[166:167], v[166:167], v[70:71]
    v_pk_add_f32 v[168:169], v[168:169], v[72:73]
    v_pk_add_f32 v[170:171], v[170:171], v[74:75]
    v_pk_add_f32 v[172:173], v[172:173], v[76:77]
    v_pk_add_f32 v[174:175], v[174:175], v[78:79]
    v_pk_add_f32 v[176:177], v[176:177], v[80:81]
    v_pk_add_f32 v[178:179], v[178:179], v[82:83]
    s_waitcnt lgkmcnt(4)
    v_pk_add_f32 v[164:165], v[164:165], v[84:85]
    v_pk_add_f32 v[166:167], v[166:167], v[86:87]
    v_pk_add_f32 v[168:169], v[168:169], v[88:89]
    v_pk_add_f32 v[170:171], v[170:171], v[90:91]
    v_pk_add_f32 v[172:173], v[172:173], v[92:93]
    v_pk_add_f32 v[174:175], v[174:175], v[94:95]
    v_pk_add_f32 v[176:177], v[176:177], v[96:97]
    v_pk_add_f32 v[178:179], v[178:179], v[98:99]
    s_waitcnt lgkmcnt(0)
    v_pk_add_f32 v[164:165], v[164:165], v[100:101]
    v_pk_add_f32 v[166:167], v[166:167], v[102:103]
    v_pk_add_f32 v[168:169], v[168:169], v[104:105]
    v_pk_add_f32 v[170:171], v[170:171], v[106:107]
    v_pk_add_f32 v[172:173], v[172:173], v[108:109]
    v_pk_add_f32 v[174:175], v[174:175], v[110:111]
    v_pk_add_f32 v[176:177], v[176:177], v[112:113]
    v_pk_add_f32 v[178:179], v[178:179], v[114:115]
    v_cvt_pk_bf16_f32 v180, v164, v165
    v_cvt_pk_bf16_f32 v181, v166, v167
    v_cvt_pk_bf16_f32 v182, v168, v169
    v_cvt_pk_bf16_f32 v183, v170, v171
    v_cvt_pk_bf16_f32 v184, v172, v173
    v_cvt_pk_bf16_f32 v185, v174, v175
    v_cvt_pk_bf16_f32 v186, v176, v177
    v_cvt_pk_bf16_f32 v187, v178, v179
    buffer_store_dwordx4 v[180:183], v4, s[56:59], s73 offen
    buffer_store_dwordx4 v[184:187], v4, s[56:59], s73 offen offset:64
    s_or_b32 s73, s2, s3
    s_cbranch_scc1 L_fin
    s_sub_u32 s73, s70, 1831565812
    v_mov_b32 v10, s73
    v_mov_b32 v4, 0
    s_mov_b64 exec, 1
    buffer_store_dword v10, v4, s[32:35], 0 offen offset:0
    s_mov_b64 exec, -1
L_fin:
L_end:
    s_endpgm
L_swr_6:
    s_add_u32 s78, s78, 1
    s_cmp_lt_u32 s78, 60000
    s_cbranch_scc0 L_swx_5
    s_xor_b32 s75, s68, 1
    s_mul_i32 s75, s75, 3072
    s_add_u32 s75, s75, s76
    buffer_load_dwordx4 v[216:219], v8, s[32:35], s75 offen offset:0 sc1
    buffer_load_dwordx4 v[220:223], v8, s[32:35], s75 offen offset:1024 sc1
    buffer_load_dwordx4 v[224:227], v8, s[32:35], s75 offen offset:2048 sc1
    s_xor_b32 s75, s68, 2
    s_mul_i32 s75, s75, 3072
    s_add_u32 s75, s75, s76
    buffer_load_dwordx4 v[228:231], v8, s[32:35], s75 offen offset:0 sc1
    buffer_load_dwordx4 v[232:235], v8, s[32:35], s75 offen offset:1024 sc1
    buffer_load_dwordx4 v[236:239], v8, s[32:35], s75 offen offset:2048 sc1
    s_xor_b32 s75, s68, 3
    s_mul_i32 s75, s75, 3072
    s_add_u32 s75, s75, s76
    buffer_load_dwordx4 v[240:243], v8, s[32:35], s75 offen offset:0 sc1
    buffer_load_dwordx4 v[244:247], v8, s[32:35], s75 offen offset:1024 sc1
    buffer_load_dwordx4 v[248:251], v8, s[32:35], s75 offen offset:2048 sc1
    s_waitcnt vmcnt(0)
    s_branch L_sw_4
L_sr_9:
    s_add_u32 s78, s78, 1
    s_cmp_lt_u32 s78, 60000
    s_cbranch_scc0 L_sx_8
    s_add_u32 s73, s76, 0
    buffer_load_dwordx4 v[100:103], v8, s[32:35], s73 offen sc1
    s_add_u32 s73, s76, 2048
    buffer_load_dwordx4 v[108:111], v8, s[32:35], s73 offen sc1
    s_waitcnt vmcnt(0)
    s_branch L_s_7
L_sr_12:
    s_add_u32 s78, s78, 1
    s_cmp_lt_u32 s78, 60000
    s_cbranch_scc0 L_sx_11
    s_add_u32 s73, s76, 4096
    buffer_load_dwordx4 v[116:119], v8, s[32:35], s73 offen sc1
    s_add_u32 s73, s76, 6144
    buffer_load_dwordx4 v[124:127], v8, s[32:35], s73 offen sc1
    s_waitcnt vmcnt(0)
    s_branch L_s_10
L_sr_15:
    s_add_u32 s78, s78, 1
    s_cmp_lt_u32 s78, 60000
    s_cbranch_scc0 L_sx_14
    s_add_u32 s73, s76, 8192
    buffer_load_dwordx4 v[132:135], v8, s[32:35], s73 offen sc1
    s_add_u32 s73, s76, 10240
    buffer_load_dwordx4 v[140:143], v8, s[32:35], s73 offen sc1
    s_waitcnt vmcnt(0)
    s_branch L_s_13
L_sr_18:
    s_add_u32 s78, s78, 1
    s_cmp_lt_u32 s78, 60000
    s_cbranch_scc0 L_sx_17
    s_add_u32 s73, s76, 12288
    buffer_load_dwordx4 v[148:151], v8, s[32:35], s73 offen sc1
    s_add_u32 s73, s76, 14336
    buffer_load_dwordx4 v[156:159], v8, s[32:35], s73 offen sc1
    s_waitcnt vmcnt(0)
    s_branch L_s_16
L_sr_21:
    s_add_u32 s78, s78, 1
    s_cmp_lt_u32 s78, 60000
    s_cbranch_scc0 L_sx_20
    s_add_u32 s73, s76, 1024
    buffer_load_dwordx4 v[104:107], v8, s[32:35], s73 offen sc1
    s_add_u32 s73, s76, 3072
    buffer_load_dwordx4 v[112:115], v8, s[32:35], s73 offen sc1
    s_waitcnt vmcnt(0)
    s_branch L_s_19
L_sr_24:
    s_add_u32 s78, s78, 1
    s_cmp_lt_u32 s78, 60000
    s_cbranch_scc0 L_sx_23
    s_add_u32 s73, s76, 5120
    buffer_load_dwordx4 v[120:123], v8, s[32:35], s73 offen sc1
    s_add_u32 s73, s76, 7168
    buffer_load_dwordx4 v[128:131], v8, s[32:35], s73 offen sc1
    s_waitcnt vmcnt(0)
    s_branch L_s_22
L_sr_27:
    s_add_u32 s78, s78, 1
    s_cmp_lt_u32 s78, 60000
    s_cbranch_scc0 L_sx_26
    s_add_u32 s73, s76, 9216
    buffer_load_dwordx4 v[136:139], v8, s[32:35], s73 offen sc1
    s_add_u32 s73, s76, 11264
    buffer_load_dwordx4 v[144:147], v8, s[32:35], s73 offen sc1
    s_waitcnt vmcnt(0)
    s_branch L_s_25
L_sr_30:
    s_add_u32 s78, s78, 1
    s_cmp_lt_u32 s78, 60000
    s_cbranch_scc0 L_sx_29
    s_add_u32 s73, s76, 13312
    buffer_load_dwordx4 v[152:155], v8, s[32:35], s73 offen sc1
    s_add_u32 s73, s76, 15360
    buffer_load_dwordx4 v[160:163], v8, s[32:35], s73 offen sc1
    s_waitcnt vmcnt(0)
    s_branch L_s_28
L_xcr_3:
    s_add_u32 s78, s78, 1
    s_cmp_lt_u32 s78, 60000
    s_cbranch_scc0 L_xcx_2
    buffer_load_dwordx2 v[200:201], v202, s[32:35], s18 offen sc1
    s_waitcnt vmcnt(0)
    s_branch L_xc_1
L_slow_31:
    buffer_store_dwordx2 v[184:185], v4, s[32:35], s13 offen sc1
    buffer_store_dwordx2 v[186:187], v4, s[32:35], s14 offen sc1
    buffer_store_dwordx2 v[188:189], v4, s[32:35], s74 offen sc1
    buffer_store_dwordx2 v[190:191], v4, s[32:35], s75 offen sc1
    s_branch L_join_32
L_slow_33:
    buffer_store_dword v209, v208, s[32:35], s73 offen sc1
    s_branch L_join_34
L_slow_38:
    buffer_store_dwordx4 v[36:39], v14, s[32:35], s73 offen offset:0 sc1
    buffer_store_dwordx4 v[40:43], v14, s[32:35], s73 offen offset:2048 sc1
    s_branch L_join_39
L_slow_40:
    buffer_store_dword v208, v13, s[32:35], s74 offen sc1
    s_branch L_join_41
L_slow_42:
    buffer_store_dword v213, v212, s[32:35], s75 offen sc1
    s_branch L_join_43
L_idle3:
    s_barrier
    s_lshl_b32 s77, s66, 1
    s_add_u32 s77, s77, s93
    s_lshl_b32 s77, s77, 3
    s_add_u32 s77, s77, s67
    s_lshl_b32 s77, s77, 1
    s_add_u32 s77, s77, s92
    s_and_b32 s75, s77, 15
    s_lshr_b32 s77, s77, 4
    s_mul_i32 s77, s77, 88064
    s_mul_i32 s75, s75, 3456
    s_add_u32 s77, s77, s75
    s_add_u32 s77, s77, 10518528
    v_min_u32 v216, 26, v1
    v_lshlrev_b32 v216, 7, v216
    buffer_load_dword v217, v216, s[32:35], s77 offen sc1
    s_add_u32 m0, s20, 8192
    s_nop 0
    buffer_load_dwordx4 v20, s[44:47], s26 offen offset:0 lds
    buffer_load_dwordx4 v21, s[44:47], s26 offen offset:1024 lds
    buffer_load_dwordx4 v22, s[44:47], s26 offen offset:2048 lds
    buffer_load_dwordx4 v23, s[44:47], s26 offen offset:3072 lds
    s_add_u32 m0, s20, 12288
    s_nop 0
    buffer_load_dwordx4 v20, s[44:47], s27 offen offset:0 lds
    buffer_load_dwordx4 v21, s[44:47], s27 offen offset:1024 lds
    buffer_load_dwordx4 v22, s[44:47], s27 offen offset:2048 lds
    buffer_load_dwordx4 v23, s[44:47], s27 offen offset:3072 lds
    s_add_u32 m0, s21, 0
    s_nop 0
    buffer_load_dwordx4 v20, s[44:47], s28 offen offset:0 lds
    buffer_load_dwordx4 v21, s[44:47], s28 offen offset:1024 lds
    buffer_load_dwordx4 v22, s[44:47], s28 offen offset:2048 lds
    buffer_load_dwordx4 v23, s[44:47], s28 offen offset:3072 lds
    s_add_u32 m0, s21, 4096
    s_nop 0
    buffer_load_dwordx4 v20, s[44:47], s29 offen offset:0 lds
    buffer_load_dwordx4 v21, s[44:47], s29 offen offset:1024 lds
    s_add_u32 m0, s21, 24576
    s_nop 0
    buffer_load_dwordx4 v20, s[44:47], s30 offen offset:0 lds
    buffer_load_dwordx4 v21, s[44:47], s30 offen offset:1024 lds
    buffer_load_dwordx4 v22, s[44:47], s30 offen offset:2048 lds
    buffer_load_dwordx4 v23, s[44:47], s30 offen offset:3072 lds
    s_add_u32 m0, s21, 28672
    s_nop 0
    buffer_load_dwordx4 v20, s[44:47], s31 offen offset:0 lds
    buffer_load_dwordx4 v21, s[44:47], s31 offen offset:1024 lds
    s_add_u32 m0, s21, 49152
    s_nop 0
    buffer_load_dwordx4 v20, s[44:47], s60 offen offset:0 lds
    buffer_load_dwordx4 v21, s[44:47], s60 offen offset:1024 lds
    buffer_load_dwordx4 v22, s[44:47], s60 offen offset:2048 lds
    buffer_load_dwordx4 v23, s[44:47], s60 offen offset:3072 lds
    s_add_u32 m0, s21, 53248
    s_nop 0
    buffer_load_dwordx4 v20, s[44:47], s61 offen offset:0 lds
    buffer_load_dwordx4 v21, s[44:47], s61 offen offset:1024 lds
    s_add_u32 m0, s21, 73728
    s_nop 0
    buffer_load_dwordx4 v20, s[44:47], s62 offen offset:0 lds
    buffer_load_dwordx4 v21, s[44:47], s62 offen offset:1024 lds
    buffer_load_dwordx4 v22, s[44:47], s62 offen offset:2048 lds
    buffer_load_dwordx4 v23, s[44:47], s62 offen offset:3072 lds
    s_add_u32 m0, s21, 77824
    s_nop 0
    buffer_load_dwordx4 v20, s[44:47], s63 offen offset:0 lds
    buffer_load_dwordx4 v21, s[44:47], s63 offen offset:1024 lds
    s_waitcnt vmcnt(0)
    s_branch L_p4
L_slow_46:
    buffer_store_dwordx4 v[168:171], v8, s[32:35], s75 offen offset:0 sc1
    buffer_store_dwordx4 v[172:175], v8, s[32:35], s75 offen offset:1024 sc1
    s_branch L_join_47
L_g3last:
    buffer_load_dwordx4 v22, s[44:47], s27 offen offset:2048 lds
    buffer_load_dwordx4 v23, s[44:47], s27 offen offset:3072 lds
    s_add_u32 m0, s21, 49152
    s_nop 0
    buffer_load_dwordx4 v20, s[44:47], s60 offen offset:0 lds
    buffer_load_dwordx4 v21, s[44:47], s60 offen offset:1024 lds
    buffer_load_dwordx4 v22, s[44:47], s60 offen offset:2048 lds
    buffer_load_dwordx4 v23, s[44:47], s60 offen offset:3072 lds
    s_add_u32 m0, s21, 53248
    s_nop 0
    buffer_load_dwordx4 v20, s[44:47], s61 offen offset:0 lds
    buffer_load_dwordx4 v21, s[44:47], s61 offen offset:1024 lds
    s_add_u32 m0, s21, 73728
    s_nop 0
    buffer_load_dwordx4 v20, s[44:47], s62 offen offset:0 lds
    buffer_load_dwordx4 v21, s[44:47], s62 offen offset:1024 lds
    buffer_load_dwordx4 v22, s[44:47], s62 offen offset:2048 lds
    buffer_load_dwordx4 v23, s[44:47], s62 offen offset:3072 lds
    s_add_u32 m0, s21, 77824
    s_nop 0
    buffer_load_dwordx4 v20, s[44:47], s63 offen offset:0 lds
    buffer_load_dwordx4 v21, s[44:47], s63 offen offset:1024 lds
    s_branch L_g3done
L_slow_48:
    buffer_store_dwordx4 v[176:179], v8, s[32:35], s75 offen offset:2048 sc1
    buffer_store_dwordx4 v[180:183], v8, s[32:35], s75 offen offset:3072 sc1
    s_branch L_join_49
L_slow_50:
    buffer_store_dwordx4 v[184:187], v8, s[32:35], s75 offen offset:0 sc1
    buffer_store_dwordx4 v[188:191], v8, s[32:35], s75 offen offset:1024 sc1
    s_branch L_join_51
L_slow_52:
    buffer_store_dword v209, v208, s[32:35], s73 offen sc1
    s_branch L_join_53
L_last:
    s_endpgm
.section .rodata,"a"
.p2align 6
.amdhsa_kernel sequential_preLN__linear_kernel_hedgehog__dense_activation_gelu__prompt_kernel
  .amdhsa_next_free_vgpr 512
  .amdhsa_next_free_sgpr 102
  .amdhsa_accum_offset 256
  .amdhsa_group_segment_fixed_size 0
  .amdhsa_kernarg_size 96
  .amdhsa_user_sgpr_count 2
  .amdhsa_user_sgpr_kernarg_segment_ptr 1
  .amdhsa_system_sgpr_workgroup_id_x 1
.end_amdhsa_kernel
```
